```python
import torch

def _softmax(x, axis=-1):
    return torch.softmax(x, dim=axis)
def _gelu(x):
    return torch.nn.functional.gelu(x, approximate="tanh")
def _silu(x):
    return torch.nn.functional.silu(x)
def _sigmoid(x):
    return torch.sigmoid(x)
def _layernorm(x, axis=-1, eps=1e-5):
    m = x.mean(dim=axis, keepdim=True)
    v = x.var(dim=axis, keepdim=True, unbiased=False)
    return (x - m) / torch.sqrt(v + eps)
def _scatter_add(tgt, idx, src, axis=0):
    return tgt.clone().index_add_(axis, idx, src)
def _segment_sum(src, seg, n):
    out = torch.zeros((n,) + src.shape[1:], dtype=src.dtype)
    return out.index_add_(0, seg, src)
def _pad(x, pw):
    flat = tuple(v for pair in reversed(pw) for v in pair)
    return torch.nn.functional.pad(x, flat)

kernel_name = 'gated_mix__linear_attn_block__linear_kernel_hedgehog__prompt'

def setup_inputs():

    _w = (lambda a: (lambda t: t.to(torch.bfloat16) if t.is_floating_point() else t)(torch.as_tensor(a)))
    def _A_setup():
        B, S, D = 1, 2048, 512
        return {
            "x": _w((lambda *s: torch.randn(*s, dtype=torch.bfloat16) * 0.05)(B, S, D)),
            "wqkv": _w((lambda *s: torch.randn(*s, dtype=torch.bfloat16) * 0.4)(D, 3 * D)),
            "wo": _w((lambda *s: torch.randn(*s, dtype=torch.bfloat16) * 0.1)(D, D)),
        }
    _A_in = _A_setup()

    def _B_setup():
        B, S, D, H = 1, 2048, 512, 32
        Dh = D // H
        return {
            "x": _w((lambda *s: torch.randn(*s, dtype=torch.bfloat16) * 0.05)(B, S, D)),
            "wqkv": _w((lambda *s: torch.randn(*s, dtype=torch.bfloat16) * 0.8)(D, 3 * D)),
            "w_phi": _w((lambda *s: torch.randn(*s, dtype=torch.bfloat16) * 0.8)(H, Dh, Dh) * (Dh ** -0.5)),
            "wo": _w((lambda *s: torch.randn(*s, dtype=torch.bfloat16) * 0.05)(D, D)),
        }
    _B_in = _B_setup()

    return {
        "A_x": _A_in["x"],
        "A_wqkv": _A_in["wqkv"],
        "A_wo": _A_in["wo"],
        "B_x": _B_in["x"],
        "B_wqkv": _B_in["wqkv"],
        "B_w_phi": _B_in["w_phi"],
        "B_wo": _B_in["wo"],
        "gate_w": _w((lambda *s: torch.randn(*s, dtype=torch.bfloat16) * 0.05)(512) * 16.0),
    }

def reference(A_x, A_wqkv, A_wo, B_x, B_wqkv, B_w_phi, B_wo, gate_w):
    def _A_ref(x, wqkv, wo):
        B, S, D = x.shape
        H = 32; Dh = D // H
        qkv = (lambda x, *d: x.permute(*d))((x @ wqkv).reshape(B, S, 3, H, Dh), 2, 0, 3, 1, 4)
        q, k, v = qkv[0], qkv[1], qkv[2]
        phi = lambda t: torch.where(t > 0, t + 1, torch.exp(t)) + 1e-6
        pq, pk = phi(q), phi(k)
        kv = torch.einsum("bhsd,bhse->bhde", pk, v)
        z = torch.einsum("bhsd->bhd", pk)
        num = torch.einsum("bhqd,bhde->bhqe", pq, kv)
        den = torch.einsum("bhqd,bhd->bhq", pq, z)[..., None] + 1e-6
        o = num / den
        return (lambda x, *d: x.permute(*d))(o, 0, 2, 1, 3).reshape(B, S, D) @ wo

    def _B_ref(x, wqkv, w_phi, wo):
        B, S, D = x.shape
        H = 32; Dh = D // H
        qkv = (lambda x, *d: x.permute(*d))((x @ wqkv).reshape(B, S, 3, H, Dh), 2, 0, 3, 1, 4)
        q, k, v = qkv[0], qkv[1], qkv[2]
        pq = torch.einsum("bhsd,hdf->bhsf", q, w_phi)
        pk = torch.einsum("bhsd,hdf->bhsf", k, w_phi)
        phi_q = torch.concatenate([_softmax(pq, axis=-1), _softmax(-pq, axis=-1)], axis=-1)
        phi_k = torch.concatenate([_softmax(pk, axis=-1), _softmax(-pk, axis=-1)], axis=-1)
        kv = torch.einsum("bhsf,bhsd->bhfd", phi_k, v)
        z  = torch.einsum("bhsf->bhf", phi_k)
        num = torch.einsum("bhqf,bhfd->bhqd", phi_q, kv)
        den = torch.einsum("bhqf,bhf->bhq", phi_q, z)[..., None] + 1e-6
        o = num / den
        return (lambda x, *d: x.permute(*d))(o, 0, 2, 1, 3).reshape(B, S, D) @ wo

    x = A_x
    g = _sigmoid((x * gate_w).sum(-1, keepdims=True))
    a = _A_ref(x, A_wqkv, A_wo)
    b = _B_ref(x, B_wqkv, B_w_phi, B_wo)
    return g * a + (1 - g) * b
```

```asm
; @launch grid=(256,1,1) block=(256,1,1) lds=163840
.amdgcn_target "amdgcn-amd-amdhsa--gfx950"
.text
.globl gated_mix__linear_attn_block__linear_kernel_hedgehog__prompt_kernel
.p2align 8
.type gated_mix__linear_attn_block__linear_kernel_hedgehog__prompt_kernel,@function
gated_mix__linear_attn_block__linear_kernel_hedgehog__prompt_kernel:
    s_cmp_ge_u32 s2, 256
    s_cbranch_scc1 L_end
    s_load_dwordx16 s[64:79], s[0:1], 0
    s_load_dwordx2 s[80:81], s[0:1], 64
    s_load_dwordx2 s[82:83], s[0:1], 80
    s_mov_b32 s92, s2
    s_and_b32 s53, s2, 7
    s_lshr_b32 s54, s2, 3
    s_and_b32 s43, s53, 1
    s_lshl_b32 s43, s43, 3
    s_and_b32 s55, s54, 7
    s_add_u32 s43, s43, s55
    s_lshr_b32 s56, s53, 1
    s_lshl_b32 s56, s56, 2
    s_lshr_b32 s55, s54, 3
    s_add_u32 s56, s56, s55
    s_lshr_b32 s44, s56, 1
    s_lshl_b32 s45, s56, 1
    s_add_u32 s45, s45, s43
    s_and_b32 s45, s45, 7
    s_and_b32 s55, s56, 1
    s_lshl_b32 s57, s53, 2
    s_and_b32 s56, s54, 3
    s_add_u32 s57, s57, s56
    s_lshr_b32 s58, s54, 2
    s_cmp_eq_u32 s55, 0
    s_cbranch_scc0 L_pathB
L_pathA:
    v_lshrrev_b32 v27, 6, v0
    v_and_b32 v1, 63, v0
    v_readfirstlane_b32 s40, v27
    v_lshrrev_b32 v27, 3, v1
    v_and_b32 v28, 7, v1
    v_lshrrev_b32 v29, 4, v1
    v_add_u32 v30, 0, v29
    v_xor_b32 v30, v28, v30
    v_lshlrev_b32 v30, 4, v30
    v_add_u32 v31, 0, v27
    v_lshl_add_u32 v17, v31, 10, v30
    v_add_u32 v30, 4, v29
    v_xor_b32 v30, v28, v30
    v_lshlrev_b32 v30, 4, v30
    v_add_u32 v31, 7, v27
    v_lshl_add_u32 v18, v31, 10, v30
    v_add_u32 v19, 14336, v17
    v_add_u32 v20, 14336, v18
    v_and_b32 v30, 1, v29
    v_lshlrev_b32 v30, 2, v30
    v_xor_b32 v30, v28, v30
    v_lshlrev_b32 v30, 4, v30
    v_mul_u32_u24 v31, 3072, v27
    v_add_u32 v21, v30, v31
    v_add_u32 v22, 23552, v21
    v_add_u32 v23, 47104, v21
    v_add_u32 v24, 70656, v21
    s_and_b32 s41, s40, 1
    s_lshr_b32 s42, s40, 1
    s_lshl_b32 s47, s43, 17
    s_lshl_b32 s53, s40, 15
    s_add_u32 s47, s47, s53
    s_lshl_b32 s60, s44, 7
    s_mul_i32 s53, s41, 98304
    s_add_u32 s48, s60, s53
    s_add_u32 s53, s42, 1
    s_lshl_b32 s53, s53, 10
    s_add_u32 s48, s48, s53
    s_lshl_b32 s49, s40, 12
    s_lshl_b32 s50, s42, 13
    s_lshl_b32 s53, s41, 12
    s_add_u32 s50, s50, s53
    s_add_u32 s50, s50, 16384
    s_lshl_b32 s61, s40, 11
    s_mul_i32 s53, s40, 49152
    s_add_u32 s53, s53, s60
    s_sub_u32 s4, s48, s53
    s_add_u32 s53, s45, 0
    s_and_b32 s53, s53, 7
    s_lshl_b32 s54, s53, 7
    s_add_u32 s51, s47, s54
    s_mul_i32 s54, s53, 196608
    s_add_u32 s52, s48, s54
    s_sub_u32 s5, s52, s4
    s_waitcnt lgkmcnt(0)
    s_mov_b32 s8, s64
    s_and_b32 s9, s65, 0xffff
    s_mov_b32 s10, 0x200000
    s_mov_b32 s11, 0x00020000
    s_mov_b32 s12, s66
    s_and_b32 s13, s67, 0xffff
    s_mov_b32 s14, 0x180000
    s_mov_b32 s15, 0x00020000
    s_add_u32 m0, s49, 0
    s_nop 0
    buffer_load_dwordx4 v17, s[8:11], s51 offen lds
    buffer_load_dwordx4 v18, s[8:11], s51 offen offset:1024 lds
    buffer_load_dwordx4 v19, s[8:11], s51 offen offset:2048 lds
    buffer_load_dwordx4 v20, s[8:11], s51 offen offset:3072 lds
    s_add_u32 m0, s50, 0
    s_nop 0
    buffer_load_dwordx4 v21, s[12:15], s52 offen lds
    buffer_load_dwordx4 v22, s[12:15], s52 offen offset:1024 lds
    buffer_load_dwordx4 v23, s[12:15], s52 offen offset:2048 lds
    buffer_load_dwordx4 v24, s[12:15], s52 offen offset:3072 lds
    s_getpc_b64 s[98:99]
L_pcA:
    s_sub_u32 s98, s98, L_pcA-gated_mix__linear_attn_block__linear_kernel_hedgehog__prompt_kernel
    s_subb_u32 s99, s99, 0
    s_lshr_b32 s53, s92, 3
    s_lshl_b32 s53, s53, 2
    s_add_u32 s53, s53, s40
    s_lshl_b32 s53, s53, 9
    v_lshlrev_b32 v27, 7, v1
    v_and_b32 v27, 0x1ff, v27
    v_add_u32 v27, s53, v27
    v_min_u32 v27, L_end-gated_mix__linear_attn_block__linear_kernel_hedgehog__prompt_kernel, v27
    v_mov_b32 v29, s99
    v_add_co_u32 v28, vcc, s98, v27
    s_nop 1
    v_addc_co_u32 v29, vcc, 0, v29, vcc
    s_mov_b64 exec, 15
    global_load_dword v239, v[28:29], off
    s_mov_b64 exec, -1
    s_mov_b32 s24, s82
    s_and_b32 s25, s83, 0xffff
    s_mov_b32 s26, 0x1000000
    s_mov_b32 s27, 0x00020000
    s_mov_b32 s32, s78
    s_and_b32 s33, s79, 0xffff
    s_mov_b32 s34, 0x400
    s_mov_b32 s35, 0x00020000
    v_mov_b32 v28, 0
    buffer_load_dword v26, v28, s[24:27], 0 offen sc1
    s_mov_b32 s16, s68
    s_and_b32 s17, s69, 0xffff
    s_mov_b32 s18, 0x80000
    s_mov_b32 s19, 0x00020000
    s_mov_b32 s20, s76
    s_and_b32 s21, s77, 0xffff
    s_mov_b32 s22, 0x80000
    s_mov_b32 s23, 0x00020000
    s_mov_b32 s28, s80
    s_and_b32 s29, s81, 0xffff
    s_mov_b32 s30, 0x200000
    s_mov_b32 s31, 0x00020000
    s_add_u32 s53, s45, 2
    s_and_b32 s53, s53, 7
    s_lshl_b32 s54, s53, 7
    s_add_u32 s66, s47, s54
    s_mul_i32 s54, s53, 196608
    s_add_u32 s67, s48, s54
    s_add_u32 s53, s45, 4
    s_and_b32 s53, s53, 7
    s_lshl_b32 s54, s53, 7
    s_add_u32 s68, s47, s54
    s_mul_i32 s54, s53, 196608
    s_add_u32 s69, s48, s54
    s_add_u32 s53, s45, 6
    s_and_b32 s53, s53, 7
    s_lshl_b32 s54, s53, 7
    s_add_u32 s70, s47, s54
    s_mul_i32 s54, s53, 196608
    s_add_u32 s71, s48, s54
    s_add_u32 s53, s45, 1
    s_and_b32 s53, s53, 7
    s_lshl_b32 s54, s53, 7
    s_add_u32 s72, s47, s54
    s_mul_i32 s54, s53, 196608
    s_add_u32 s73, s48, s54
    s_add_u32 s53, s45, 3
    s_and_b32 s53, s53, 7
    s_lshl_b32 s54, s53, 7
    s_add_u32 s74, s47, s54
    s_mul_i32 s54, s53, 196608
    s_add_u32 s75, s48, s54
    s_add_u32 s53, s45, 5
    s_and_b32 s53, s53, 7
    s_lshl_b32 s54, s53, 7
    s_add_u32 s76, s47, s54
    s_mul_i32 s54, s53, 196608
    s_add_u32 s77, s48, s54
    s_add_u32 s53, s45, 7
    s_and_b32 s53, s53, 7
    s_lshl_b32 s54, s53, 7
    s_add_u32 s78, s47, s54
    s_mul_i32 s54, s53, 196608
    s_add_u32 s79, s48, s54
    s_lshl_b32 s53, s44, 18
    s_add_u32 s53, s53, 8388608
    buffer_load_dword v232, v28, s[24:27], s53 offen
    s_lshl_b32 s53, s43, 18
    s_add_u32 s53, s53, 2097152
    buffer_load_dword v233, v28, s[24:27], s53 offen
    s_lshl_b32 s53, s57, 17
    s_add_u32 s53, s53, 2097152
    buffer_load_dword v234, v28, s[24:27], s53 offen
    buffer_load_dword v235, v28, s[16:19], 0 offen
    buffer_load_dword v236, v28, s[20:23], 0 offen
    s_lshl_b32 s53, s57, 16
    buffer_load_dword v237, v28, s[28:31], s53 offen
    v_lshrrev_b32 v27, 3, v1
    v_and_b32 v28, 7, v1
    v_bfe_u32 v29, v1, 4, 1
    v_lshlrev_b32 v29, 2, v29
    v_xor_b32 v28, v28, v29
    v_lshlrev_b32 v28, 4, v28
    s_lshl_b32 s53, s58, 7
    v_add_u32 v28, s53, v28
    v_lshl_add_u32 v10, v27, 10, v28
    v_add_u32 v11, 7168, v10
    v_add_u32 v12, 14336, v10
    v_add_u32 v13, 21504, v10
    s_lshl_b32 s96, s40, 16
    s_lshl_b32 s97, s40, 13
    s_and_b32 s6, s57, 3
    s_lshr_b32 s53, s6, 1
    s_lshl_b32 s53, s53, 18
    s_add_u32 s96, s96, s53
    s_bitcmp1_b32 s6, 0
    s_cselect_b32 s53, s20, s16
    s_cselect_b32 s54, s16, s20
    s_cselect_b32 s98, s21, s17
    s_cselect_b32 s99, s17, s21
    s_mov_b32 s16, s53
    s_mov_b32 s20, s54
    s_mov_b32 s17, s98
    s_mov_b32 s21, s99
    v_and_b32 v27, 31, v1
    v_lshrrev_b32 v28, 5, v1
    v_lshrrev_b32 v29, 1, v27
    v_and_b32 v29, 7, v29
    v_xor_b32 v29, v28, v29
    s_lshl_b32 s53, s41, 13
    v_lshlrev_b32 v30, 7, v27
    v_add_u32 v30, s53, v30
    v_xor_b32 v31, 0, v29
    v_lshl_add_u32 v2, v31, 4, v30
    v_add_u32 v6, 0x10000, v2
    v_xor_b32 v31, 2, v29
    v_lshl_add_u32 v3, v31, 4, v30
    v_add_u32 v7, 0x10000, v3
    v_xor_b32 v31, 4, v29
    v_lshl_add_u32 v4, v31, 4, v30
    v_add_u32 v8, 0x10000, v4
    v_xor_b32 v31, 6, v29
    v_lshl_add_u32 v5, v31, 4, v30
    v_add_u32 v9, 0x10000, v5
    v_lshrrev_b32 v27, 2, v1
    v_and_b32 v27, 3, v27
    v_lshl_add_u32 v29, v28, 3, v27
    v_lshlrev_b32 v29, 7, v29
    v_lshrrev_b32 v30, 1, v27
    v_xor_b32 v30, s42, v30
    v_lshl_add_u32 v29, v30, 6, v29
    v_lshrrev_b32 v30, 4, v1
    v_xor_b32 v30, s41, v30
    v_and_b32 v30, 1, v30
    v_lshl_add_u32 v29, v30, 5, v29
    v_and_b32 v30, 3, v1
    v_lshl_add_u32 v14, v30, 3, v29
    v_add_u32 v15, 0x10000, v14
    v_add_u32 v16, 0x20000, v14
    v_mov_b32 v25, 0x3f803f80
    s_mov_b32 s62, 0xffff0000
    s_mov_b32 s63, 0xffff0000
    s_mov_b32 s84, 0x3fb8aa3b
    s_mov_b32 s85, 0x3fb8aa3b
    s_mov_b32 s86, 0x358637bd
    s_mov_b32 s87, 0x358637bd
    s_mov_b32 s94, 0xaaaaaaaa
    s_mov_b32 s95, 0xaaaaaaaa
    s_add_u32 m0, s49, 32768
    s_nop 0
    buffer_load_dwordx4 v17, s[8:11], s66 offen lds
    buffer_load_dwordx4 v18, s[8:11], s66 offen offset:1024 lds
    buffer_load_dwordx4 v19, s[8:11], s66 offen offset:2048 lds
    buffer_load_dwordx4 v20, s[8:11], s66 offen offset:3072 lds
    s_add_u32 m0, s50, 32768
    s_nop 0
    buffer_load_dwordx4 v21, s[12:15], s67 offen lds
    buffer_load_dwordx4 v22, s[12:15], s67 offen offset:1024 lds
    buffer_load_dwordx4 v23, s[12:15], s67 offen offset:2048 lds
    buffer_load_dwordx4 v24, s[12:15], s67 offen offset:3072 lds
    s_waitcnt vmcnt(16)
    s_barrier
    ds_read_b64_tr_b16 v[128:129], v14 offset:16384
    ds_read_b64_tr_b16 v[130:131], v14 offset:16896
    ds_read_b64_tr_b16 v[132:133], v14 offset:24576
    ds_read_b64_tr_b16 v[134:135], v14 offset:25088
    ds_read_b128 a[0:3], v2 offset:0
    ds_read_b128 a[4:7], v2 offset:4096
    ds_read_b64_tr_b16 v[136:137], v14 offset:18432
    ds_read_b64_tr_b16 v[138:139], v14 offset:18944
    ds_read_b64_tr_b16 v[140:141], v14 offset:26624
    ds_read_b64_tr_b16 v[142:143], v14 offset:27136
    ds_read_b128 a[8:11], v3 offset:0
    ds_read_b128 a[12:15], v3 offset:4096
    s_waitcnt lgkmcnt(6)
    v_mfma_f32_32x32x16_bf16 v[32:47], a[0:3], v[128:131], 0
    ds_read_b64_tr_b16 v[144:145], v14 offset:20480
    v_mfma_f32_32x32x16_bf16 v[64:79], a[0:3], v[132:135], 0
    ds_read_b64_tr_b16 v[146:147], v14 offset:20992
    ds_read_b64_tr_b16 v[148:149], v14 offset:28672
    s_add_u32 m0, s49, 65536
    s_nop 0
    buffer_load_dwordx4 v17, s[8:11], s68 offen lds
    v_mfma_f32_32x32x16_bf16 v[48:63], a[4:7], v[128:131], 0
    ds_read_b64_tr_b16 v[150:151], v14 offset:29184
    v_mfma_f32_32x32x16_bf16 v[80:95], a[4:7], v[132:135], 0
    ds_read_b128 a[16:19], v4 offset:0
    ds_read_b128 a[20:23], v4 offset:4096
    buffer_load_dwordx4 v18, s[8:11], s68 offen offset:1024 lds
    s_waitcnt lgkmcnt(6)
    v_mfma_f32_32x32x16_bf16 v[32:47], a[8:11], v[136:139], v[32:47]
    ds_read_b64_tr_b16 v[128:129], v14 offset:22528
    v_mfma_f32_32x32x16_bf16 v[64:79], a[8:11], v[140:143], v[64:79]
    ds_read_b64_tr_b16 v[130:131], v14 offset:23040
    ds_read_b64_tr_b16 v[132:133], v14 offset:30720
    buffer_load_dwordx4 v19, s[8:11], s68 offen offset:2048 lds
    v_mfma_f32_32x32x16_bf16 v[48:63], a[12:15], v[136:139], v[48:63]
    ds_read_b64_tr_b16 v[134:135], v14 offset:31232
    v_mfma_f32_32x32x16_bf16 v[80:95], a[12:15], v[140:143], v[80:95]
    ds_read_b128 a[24:27], v5 offset:0
    ds_read_b128 a[28:31], v5 offset:4096
    buffer_load_dwordx4 v20, s[8:11], s68 offen offset:3072 lds
    s_waitcnt lgkmcnt(6)
    v_mfma_f32_32x32x16_bf16 v[32:47], a[16:19], v[144:147], v[32:47]
    s_waitcnt vmcnt(4)
    s_barrier
    ds_read_b64_tr_b16 v[136:137], v14 offset:49152
    s_add_u32 m0, s50, 65536
    s_nop 0
    buffer_load_dwordx4 v21, s[12:15], s69 offen lds
    v_mfma_f32_32x32x16_bf16 v[64:79], a[16:19], v[148:151], v[64:79]
    ds_read_b64_tr_b16 v[138:139], v14 offset:49664
    ds_read_b64_tr_b16 v[140:141], v14 offset:57344
    buffer_load_dwordx4 v22, s[12:15], s69 offen offset:1024 lds
    v_mfma_f32_32x32x16_bf16 v[48:63], a[20:23], v[144:147], v[48:63]
    ds_read_b64_tr_b16 v[142:143], v14 offset:57856
    buffer_load_dwordx4 v23, s[12:15], s69 offen offset:2048 lds
    v_mfma_f32_32x32x16_bf16 v[80:95], a[20:23], v[148:151], v[80:95]
    ds_read_b128 a[32:35], v2 offset:32768
    ds_read_b128 a[36:39], v2 offset:36864
    buffer_load_dwordx4 v24, s[12:15], s69 offen offset:3072 lds
    s_waitcnt lgkmcnt(6)
    v_mfma_f32_32x32x16_bf16 v[32:47], a[24:27], v[128:131], v[32:47]
    ds_read_b64_tr_b16 v[144:145], v14 offset:51200
    v_mfma_f32_32x32x16_bf16 v[64:79], a[24:27], v[132:135], v[64:79]
    ds_read_b64_tr_b16 v[146:147], v14 offset:51712
    ds_read_b64_tr_b16 v[148:149], v14 offset:59392
    s_add_u32 m0, s49, 98304
    s_nop 0
    buffer_load_dwordx4 v17, s[8:11], s70 offen lds
    v_mfma_f32_32x32x16_bf16 v[48:63], a[28:31], v[128:131], v[48:63]
    ds_read_b64_tr_b16 v[150:151], v14 offset:59904
    v_mfma_f32_32x32x16_bf16 v[80:95], a[28:31], v[132:135], v[80:95]
    ds_read_b128 a[40:43], v3 offset:32768
    ds_read_b128 a[44:47], v3 offset:36864
    buffer_load_dwordx4 v18, s[8:11], s70 offen offset:1024 lds
    s_waitcnt lgkmcnt(6)
    v_mfma_f32_32x32x16_bf16 v[32:47], a[32:35], v[136:139], v[32:47]
    ds_read_b64_tr_b16 v[128:129], v14 offset:53248
    v_mfma_f32_32x32x16_bf16 v[64:79], a[32:35], v[140:143], v[64:79]
    ds_read_b64_tr_b16 v[130:131], v14 offset:53760
    ds_read_b64_tr_b16 v[132:133], v14 offset:61440
    buffer_load_dwordx4 v19, s[8:11], s70 offen offset:2048 lds
    v_mfma_f32_32x32x16_bf16 v[48:63], a[36:39], v[136:139], v[48:63]
    ds_read_b64_tr_b16 v[134:135], v14 offset:61952
    v_mfma_f32_32x32x16_bf16 v[80:95], a[36:39], v[140:143], v[80:95]
    ds_read_b128 a[48:51], v4 offset:32768
    ds_read_b128 a[52:55], v4 offset:36864
    buffer_load_dwordx4 v20, s[8:11], s70 offen offset:3072 lds
    s_waitcnt lgkmcnt(6)
    v_mfma_f32_32x32x16_bf16 v[32:47], a[40:43], v[144:147], v[32:47]
    ds_read_b64_tr_b16 v[136:137], v14 offset:55296
    v_mfma_f32_32x32x16_bf16 v[64:79], a[40:43], v[148:151], v[64:79]
    ds_read_b64_tr_b16 v[138:139], v14 offset:55808
    ds_read_b64_tr_b16 v[140:141], v14 offset:63488
    s_add_u32 m0, s50, 98304
    s_nop 0
    buffer_load_dwordx4 v21, s[12:15], s71 offen lds
    v_mfma_f32_32x32x16_bf16 v[48:63], a[44:47], v[144:147], v[48:63]
    ds_read_b64_tr_b16 v[142:143], v14 offset:64000
    v_mfma_f32_32x32x16_bf16 v[80:95], a[44:47], v[148:151], v[80:95]
    ds_read_b128 a[56:59], v5 offset:32768
    ds_read_b128 a[60:63], v5 offset:36864
    buffer_load_dwordx4 v22, s[12:15], s71 offen offset:1024 lds
    s_waitcnt lgkmcnt(6)
    v_mfma_f32_32x32x16_bf16 v[32:47], a[48:51], v[128:131], v[32:47]
    s_waitcnt vmcnt(6)
    s_barrier
    ds_read_b64_tr_b16 v[144:145], v15 offset:16384
    buffer_load_dwordx4 v23, s[12:15], s71 offen offset:2048 lds
    v_mfma_f32_32x32x16_bf16 v[64:79], a[48:51], v[132:135], v[64:79]
    ds_read_b64_tr_b16 v[146:147], v15 offset:16896
    ds_read_b64_tr_b16 v[148:149], v15 offset:24576
    buffer_load_dwordx4 v24, s[12:15], s71 offen offset:3072 lds
    v_mfma_f32_32x32x16_bf16 v[48:63], a[52:55], v[128:131], v[48:63]
    ds_read_b64_tr_b16 v[150:151], v15 offset:25088
    v_mfma_f32_32x32x16_bf16 v[80:95], a[52:55], v[132:135], v[80:95]
    ds_read_b128 a[64:67], v6 offset:0
    ds_read_b128 a[68:71], v6 offset:4096
    s_add_u32 m0, s49, 0
    s_nop 0
    buffer_load_dwordx4 v17, s[8:11], s72 offen lds
    s_waitcnt lgkmcnt(6)
    v_mfma_f32_32x32x16_bf16 v[32:47], a[56:59], v[136:139], v[32:47]
    ds_read_b64_tr_b16 v[128:129], v15 offset:18432
    v_mfma_f32_32x32x16_bf16 v[64:79], a[56:59], v[140:143], v[64:79]
    ds_read_b64_tr_b16 v[130:131], v15 offset:18944
    ds_read_b64_tr_b16 v[132:133], v15 offset:26624
    buffer_load_dwordx4 v18, s[8:11], s72 offen offset:1024 lds
    v_mfma_f32_32x32x16_bf16 v[48:63], a[60:63], v[136:139], v[48:63]
    ds_read_b64_tr_b16 v[134:135], v15 offset:27136
    v_mfma_f32_32x32x16_bf16 v[80:95], a[60:63], v[140:143], v[80:95]
    ds_read_b128 a[72:75], v7 offset:0
    ds_read_b128 a[76:79], v7 offset:4096
    buffer_load_dwordx4 v19, s[8:11], s72 offen offset:2048 lds
    s_waitcnt lgkmcnt(6)
    v_mfma_f32_32x32x16_bf16 v[32:47], a[64:67], v[144:147], v[32:47]
    ds_read_b64_tr_b16 v[136:137], v15 offset:20480
    v_mfma_f32_32x32x16_bf16 v[64:79], a[64:67], v[148:151], v[64:79]
    ds_read_b64_tr_b16 v[138:139], v15 offset:20992
    ds_read_b64_tr_b16 v[140:141], v15 offset:28672
    buffer_load_dwordx4 v20, s[8:11], s72 offen offset:3072 lds
    v_mfma_f32_32x32x16_bf16 v[48:63], a[68:71], v[144:147], v[48:63]
    ds_read_b64_tr_b16 v[142:143], v15 offset:29184
    v_mfma_f32_32x32x16_bf16 v[80:95], a[68:71], v[148:151], v[80:95]
    ds_read_b128 a[80:83], v8 offset:0
    ds_read_b128 a[84:87], v8 offset:4096
    s_add_u32 m0, s50, 0
    s_nop 0
    buffer_load_dwordx4 v21, s[12:15], s73 offen lds
    s_waitcnt lgkmcnt(6)
    v_mfma_f32_32x32x16_bf16 v[32:47], a[72:75], v[128:131], v[32:47]
    ds_read_b64_tr_b16 v[144:145], v15 offset:22528
    v_mfma_f32_32x32x16_bf16 v[64:79], a[72:75], v[132:135], v[64:79]
    ds_read_b64_tr_b16 v[146:147], v15 offset:23040
    ds_read_b64_tr_b16 v[148:149], v15 offset:30720
    buffer_load_dwordx4 v22, s[12:15], s73 offen offset:1024 lds
    v_mfma_f32_32x32x16_bf16 v[48:63], a[76:79], v[128:131], v[48:63]
    ds_read_b64_tr_b16 v[150:151], v15 offset:31232
    v_mfma_f32_32x32x16_bf16 v[80:95], a[76:79], v[132:135], v[80:95]
    ds_read_b128 a[88:91], v9 offset:0
    ds_read_b128 a[92:95], v9 offset:4096
    buffer_load_dwordx4 v23, s[12:15], s73 offen offset:2048 lds
    s_waitcnt lgkmcnt(6)
    v_mfma_f32_32x32x16_bf16 v[32:47], a[80:83], v[136:139], v[32:47]
    s_waitcnt vmcnt(7)
    s_barrier
    ds_read_b64_tr_b16 v[128:129], v15 offset:49152
    buffer_load_dwordx4 v24, s[12:15], s73 offen offset:3072 lds
    v_mfma_f32_32x32x16_bf16 v[64:79], a[80:83], v[140:143], v[64:79]
    ds_read_b64_tr_b16 v[130:131], v15 offset:49664
    ds_read_b64_tr_b16 v[132:133], v15 offset:57344
    s_add_u32 m0, s49, 32768
    s_nop 0
    buffer_load_dwordx4 v17, s[8:11], s74 offen lds
    v_mfma_f32_32x32x16_bf16 v[48:63], a[84:87], v[136:139], v[48:63]
    ds_read_b64_tr_b16 v[134:135], v15 offset:57856
    v_mfma_f32_32x32x16_bf16 v[80:95], a[84:87], v[140:143], v[80:95]
    ds_read_b128 a[96:99], v6 offset:32768
    ds_read_b128 a[100:103], v6 offset:36864
    buffer_load_dwordx4 v18, s[8:11], s74 offen offset:1024 lds
    s_waitcnt lgkmcnt(6)
    v_mfma_f32_32x32x16_bf16 v[32:47], a[88:91], v[144:147], v[32:47]
    ds_read_b64_tr_b16 v[136:137], v15 offset:51200
    v_mfma_f32_32x32x16_bf16 v[64:79], a[88:91], v[148:151], v[64:79]
    ds_read_b64_tr_b16 v[138:139], v15 offset:51712
    ds_read_b64_tr_b16 v[140:141], v15 offset:59392
    buffer_load_dwordx4 v19, s[8:11], s74 offen offset:2048 lds
    v_mfma_f32_32x32x16_bf16 v[48:63], a[92:95], v[144:147], v[48:63]
    ds_read_b64_tr_b16 v[142:143], v15 offset:59904
    v_mfma_f32_32x32x16_bf16 v[80:95], a[92:95], v[148:151], v[80:95]
    ds_read_b128 a[104:107], v7 offset:32768
    ds_read_b128 a[108:111], v7 offset:36864
    buffer_load_dwordx4 v20, s[8:11], s74 offen offset:3072 lds
    s_waitcnt lgkmcnt(6)
    v_mfma_f32_32x32x16_bf16 v[32:47], a[96:99], v[128:131], v[32:47]
    ds_read_b64_tr_b16 v[144:145], v15 offset:53248
    v_mfma_f32_32x32x16_bf16 v[64:79], a[96:99], v[132:135], v[64:79]
    ds_read_b64_tr_b16 v[146:147], v15 offset:53760
    ds_read_b64_tr_b16 v[148:149], v15 offset:61440
    s_add_u32 m0, s50, 32768
    s_nop 0
    buffer_load_dwordx4 v21, s[12:15], s75 offen lds
    v_mfma_f32_32x32x16_bf16 v[48:63], a[100:103], v[128:131], v[48:63]
    ds_read_b64_tr_b16 v[150:151], v15 offset:61952
    v_mfma_f32_32x32x16_bf16 v[80:95], a[100:103], v[132:135], v[80:95]
    ds_read_b128 a[112:115], v8 offset:32768
    ds_read_b128 a[116:119], v8 offset:36864
    buffer_load_dwordx4 v22, s[12:15], s75 offen offset:1024 lds
    s_waitcnt lgkmcnt(6)
    v_mfma_f32_32x32x16_bf16 v[32:47], a[104:107], v[136:139], v[32:47]
    ds_read_b64_tr_b16 v[128:129], v15 offset:55296
    v_mfma_f32_32x32x16_bf16 v[64:79], a[104:107], v[140:143], v[64:79]
    ds_read_b64_tr_b16 v[130:131], v15 offset:55808
    ds_read_b64_tr_b16 v[132:133], v15 offset:63488
    buffer_load_dwordx4 v23, s[12:15], s75 offen offset:2048 lds
    v_mfma_f32_32x32x16_bf16 v[48:63], a[108:111], v[136:139], v[48:63]
    ds_read_b64_tr_b16 v[134:135], v15 offset:64000
    v_mfma_f32_32x32x16_bf16 v[80:95], a[108:111], v[140:143], v[80:95]
    ds_read_b128 a[120:123], v9 offset:32768
    ds_read_b128 a[124:127], v9 offset:36864
    buffer_load_dwordx4 v24, s[12:15], s75 offen offset:3072 lds
    s_waitcnt lgkmcnt(6)
    v_mfma_f32_32x32x16_bf16 v[32:47], a[112:115], v[144:147], v[32:47]
    s_waitcnt vmcnt(8)
    s_barrier
    ds_read_b64_tr_b16 v[136:137], v14 offset:16384
    s_add_u32 m0, s49, 65536
    s_nop 0
    buffer_load_dwordx4 v17, s[8:11], s76 offen lds
    v_mfma_f32_32x32x16_bf16 v[64:79], a[112:115], v[148:151], v[64:79]
    ds_read_b64_tr_b16 v[138:139], v14 offset:16896
    ds_read_b64_tr_b16 v[140:141], v14 offset:24576
    buffer_load_dwordx4 v18, s[8:11], s76 offen offset:1024 lds
    v_mfma_f32_32x32x16_bf16 v[48:63], a[116:119], v[144:147], v[48:63]
    ds_read_b64_tr_b16 v[142:143], v14 offset:25088
    buffer_load_dwordx4 v19, s[8:11], s76 offen offset:2048 lds
    v_mfma_f32_32x32x16_bf16 v[80:95], a[116:119], v[148:151], v[80:95]
    ds_read_b128 a[128:131], v2 offset:0
    ds_read_b128 a[132:135], v2 offset:4096
    buffer_load_dwordx4 v20, s[8:11], s76 offen offset:3072 lds
    s_waitcnt lgkmcnt(6)
    v_mfma_f32_32x32x16_bf16 v[32:47], a[120:123], v[128:131], v[32:47]
    ds_read_b64_tr_b16 v[144:145], v14 offset:18432
    s_add_u32 m0, s50, 65536
    s_nop 0
    buffer_load_dwordx4 v21, s[12:15], s77 offen lds
    v_mfma_f32_32x32x16_bf16 v[64:79], a[120:123], v[132:135], v[64:79]
    ds_read_b64_tr_b16 v[146:147], v14 offset:18944
    ds_read_b64_tr_b16 v[148:149], v14 offset:26624
    buffer_load_dwordx4 v22, s[12:15], s77 offen offset:1024 lds
    v_mfma_f32_32x32x16_bf16 v[48:63], a[124:127], v[128:131], v[48:63]
    ds_read_b64_tr_b16 v[150:151], v14 offset:27136
    buffer_load_dwordx4 v23, s[12:15], s77 offen offset:2048 lds
    v_mfma_f32_32x32x16_bf16 v[80:95], a[124:127], v[132:135], v[80:95]
    ds_read_b128 a[136:139], v3 offset:0
    ds_read_b128 a[140:143], v3 offset:4096
    buffer_load_dwordx4 v24, s[12:15], s77 offen offset:3072 lds
    s_waitcnt lgkmcnt(6)
    v_mfma_f32_32x32x16_bf16 v[32:47], a[128:131], v[136:139], v[32:47]
    ds_read_b64_tr_b16 v[128:129], v14 offset:20480
    s_lshl_b32 s53, s43, 7
    s_lshl_b32 s54, s44, 4
    s_add_u32 s53, s53, s54
    s_lshl_b32 s54, s40, 2
    s_add_u32 s53, s53, s54
    s_lshl_b32 s55, s53, 10
    v_mfma_f32_32x32x16_bf16 v[64:79], a[128:131], v[140:143], v[64:79]
    ds_read_b64_tr_b16 v[130:131], v14 offset:20992
    ds_read_b64_tr_b16 v[132:133], v14 offset:28672
    s_lshr_b32 s56, s53, 2
    s_lshl_b32 s56, s56, 7
    s_add_u32 s93, s56, 4096
    v_and_b32 v27, 15, v1
    v_lshlrev_b32 v27, 4, v27
    v_mfma_f32_32x32x16_bf16 v[48:63], a[132:135], v[136:139], v[48:63]
    ds_read_b64_tr_b16 v[134:135], v14 offset:29184
    v_lshrrev_b32 v28, 4, v1
    v_lshl_add_u32 v28, v28, 10, v27
    v_mfma_f32_32x32x16_bf16 v[80:95], a[132:135], v[140:143], v[80:95]
    ds_read_b128 a[144:147], v4 offset:0
    ds_read_b128 a[148:151], v4 offset:4096
    buffer_load_dwordx4 v[168:171], v28, s[8:11], s55 offen offset:0
    s_waitcnt lgkmcnt(6)
    v_mfma_f32_32x32x16_bf16 v[32:47], a[136:139], v[144:147], v[32:47]
    ds_read_b64_tr_b16 v[136:137], v14 offset:22528
    v_mfma_f32_32x32x16_bf16 v[64:79], a[136:139], v[148:151], v[64:79]
    ds_read_b64_tr_b16 v[138:139], v14 offset:23040
    ds_read_b64_tr_b16 v[140:141], v14 offset:30720
    buffer_load_dwordx4 v[172:175], v28, s[8:11], s55 offen offset:256
    v_mfma_f32_32x32x16_bf16 v[48:63], a[140:143], v[144:147], v[48:63]
    ds_read_b64_tr_b16 v[142:143], v14 offset:31232
    v_mfma_f32_32x32x16_bf16 v[80:95], a[140:143], v[148:151], v[80:95]
    ds_read_b128 a[152:155], v5 offset:0
    ds_read_b128 a[156:159], v5 offset:4096
    buffer_load_dwordx4 v[176:179], v28, s[8:11], s55 offen offset:512
    s_waitcnt lgkmcnt(6)
    v_mfma_f32_32x32x16_bf16 v[32:47], a[144:147], v[128:131], v[32:47]
    s_waitcnt vmcnt(11)
    s_barrier
    ds_read_b64_tr_b16 v[144:145], v14 offset:49152
    buffer_load_dwordx4 v[180:183], v28, s[8:11], s55 offen offset:768
    v_mfma_f32_32x32x16_bf16 v[64:79], a[144:147], v[132:135], v[64:79]
    ds_read_b64_tr_b16 v[146:147], v14 offset:49664
    ds_read_b64_tr_b16 v[148:149], v14 offset:57344
    buffer_load_dwordx4 v[184:187], v27, s[32:35], 0 offen offset:0
    v_mfma_f32_32x32x16_bf16 v[48:63], a[148:151], v[128:131], v[48:63]
    ds_read_b64_tr_b16 v[150:151], v14 offset:57856
    buffer_load_dwordx4 v[188:191], v27, s[32:35], 0 offen offset:256
    v_mfma_f32_32x32x16_bf16 v[80:95], a[148:151], v[132:135], v[80:95]
    ds_read_b128 a[160:163], v2 offset:32768
    ds_read_b128 a[164:167], v2 offset:36864
    buffer_load_dwordx4 v[192:195], v27, s[32:35], 0 offen offset:512
    s_waitcnt lgkmcnt(6)
    v_mfma_f32_32x32x16_bf16 v[32:47], a[152:155], v[136:139], v[32:47]
    ds_read_b64_tr_b16 v[128:129], v14 offset:51200
    buffer_load_dwordx4 v[196:199], v27, s[32:35], 0 offen offset:768
    v_mfma_f32_32x32x16_bf16 v[64:79], a[152:155], v[140:143], v[64:79]
    ds_read_b64_tr_b16 v[130:131], v14 offset:51712
    ds_read_b64_tr_b16 v[132:133], v14 offset:59392
    s_add_u32 m0, s49, 98304
    s_nop 0
    buffer_load_dwordx4 v17, s[8:11], s78 offen lds
    v_mfma_f32_32x32x16_bf16 v[48:63], a[156:159], v[136:139], v[48:63]
    ds_read_b64_tr_b16 v[134:135], v14 offset:59904
    v_mfma_f32_32x32x16_bf16 v[80:95], a[156:159], v[140:143], v[80:95]
    ds_read_b128 a[168:171], v3 offset:32768
    ds_read_b128 a[172:175], v3 offset:36864
    buffer_load_dwordx4 v18, s[8:11], s78 offen offset:1024 lds
    s_waitcnt lgkmcnt(6)
    v_mfma_f32_32x32x16_bf16 v[32:47], a[160:163], v[144:147], v[32:47]
    ds_read_b64_tr_b16 v[136:137], v14 offset:53248
    v_mfma_f32_32x32x16_bf16 v[64:79], a[160:163], v[148:151], v[64:79]
    ds_read_b64_tr_b16 v[138:139], v14 offset:53760
    ds_read_b64_tr_b16 v[140:141], v14 offset:61440
    buffer_load_dwordx4 v19, s[8:11], s78 offen offset:2048 lds
    v_mfma_f32_32x32x16_bf16 v[48:63], a[164:167], v[144:147], v[48:63]
    ds_read_b64_tr_b16 v[142:143], v14 offset:61952
    v_mfma_f32_32x32x16_bf16 v[80:95], a[164:167], v[148:151], v[80:95]
    ds_read_b128 a[176:179], v4 offset:32768
    ds_read_b128 a[180:183], v4 offset:36864
    buffer_load_dwordx4 v20, s[8:11], s78 offen offset:3072 lds
    s_waitcnt lgkmcnt(6)
    v_mfma_f32_32x32x16_bf16 v[32:47], a[168:171], v[128:131], v[32:47]
    ds_read_b64_tr_b16 v[144:145], v14 offset:55296
    v_mfma_f32_32x32x16_bf16 v[64:79], a[168:171], v[132:135], v[64:79]
    ds_read_b64_tr_b16 v[146:147], v14 offset:55808
    ds_read_b64_tr_b16 v[148:149], v14 offset:63488
    s_add_u32 m0, s50, 98304
    s_nop 0
    buffer_load_dwordx4 v21, s[12:15], s79 offen lds
    v_mfma_f32_32x32x16_bf16 v[48:63], a[172:175], v[128:131], v[48:63]
    ds_read_b64_tr_b16 v[150:151], v14 offset:64000
    v_mfma_f32_32x32x16_bf16 v[80:95], a[172:175], v[132:135], v[80:95]
    ds_read_b128 a[184:187], v5 offset:32768
    ds_read_b128 a[188:191], v5 offset:36864
    buffer_load_dwordx4 v22, s[12:15], s79 offen offset:1024 lds
    s_waitcnt lgkmcnt(6)
    v_mfma_f32_32x32x16_bf16 v[32:47], a[176:179], v[136:139], v[32:47]
    s_waitcnt vmcnt(14)
    s_barrier
    ds_read_b64_tr_b16 v[128:129], v15 offset:16384
    buffer_load_dwordx4 v23, s[12:15], s79 offen offset:2048 lds
    v_mfma_f32_32x32x16_bf16 v[64:79], a[176:179], v[140:143], v[64:79]
    ds_read_b64_tr_b16 v[130:131], v15 offset:16896
    ds_read_b64_tr_b16 v[132:133], v15 offset:24576
    buffer_load_dwordx4 v24, s[12:15], s79 offen offset:3072 lds
    v_mfma_f32_32x32x16_bf16 v[48:63], a[180:183], v[136:139], v[48:63]
    ds_read_b64_tr_b16 v[134:135], v15 offset:25088
    v_mfma_f32_32x32x16_bf16 v[80:95], a[180:183], v[140:143], v[80:95]
    ds_read_b128 a[192:195], v6 offset:0
    ds_read_b128 a[196:199], v6 offset:4096
    s_add_u32 s52, s5, 0
    s_add_u32 m0, s61, 0
    s_nop 0
    buffer_load_dwordx4 v21, s[12:15], s52 offen lds
    s_waitcnt lgkmcnt(6)
    v_mfma_f32_32x32x16_bf16 v[32:47], a[184:187], v[144:147], v[32:47]
    ds_read_b64_tr_b16 v[136:137], v15 offset:18432
    v_mfma_f32_32x32x16_bf16 v[64:79], a[184:187], v[148:151], v[64:79]
    ds_read_b64_tr_b16 v[138:139], v15 offset:18944
    ds_read_b64_tr_b16 v[140:141], v15 offset:26624
    buffer_load_dwordx4 v22, s[12:15], s52 offen offset:1024 lds
    v_mfma_f32_32x32x16_bf16 v[48:63], a[188:191], v[144:147], v[48:63]
    ds_read_b64_tr_b16 v[142:143], v15 offset:27136
    v_mfma_f32_32x32x16_bf16 v[80:95], a[188:191], v[148:151], v[80:95]
    ds_read_b128 a[200:203], v7 offset:0
    ds_read_b128 a[204:207], v7 offset:4096
    s_sub_u32 s52, s67, s4
    s_add_u32 m0, s61, 8192
    s_nop 0
    buffer_load_dwordx4 v21, s[12:15], s52 offen lds
    s_waitcnt lgkmcnt(6)
    v_mfma_f32_32x32x16_bf16 v[32:47], a[192:195], v[128:131], v[32:47]
    ds_read_b64_tr_b16 v[144:145], v15 offset:20480
    v_mfma_f32_32x32x16_bf16 v[64:79], a[192:195], v[132:135], v[64:79]
    ds_read_b64_tr_b16 v[146:147], v15 offset:20992
    ds_read_b64_tr_b16 v[148:149], v15 offset:28672
    buffer_load_dwordx4 v22, s[12:15], s52 offen offset:1024 lds
    v_mfma_f32_32x32x16_bf16 v[48:63], a[196:199], v[128:131], v[48:63]
    ds_read_b64_tr_b16 v[150:151], v15 offset:29184
    v_mfma_f32_32x32x16_bf16 v[80:95], a[196:199], v[132:135], v[80:95]
    ds_read_b128 a[208:211], v8 offset:0
    ds_read_b128 a[212:215], v8 offset:4096
    s_sub_u32 s52, s69, s4
    s_add_u32 m0, s61, 16384
    s_nop 0
    buffer_load_dwordx4 v21, s[12:15], s52 offen lds
    s_waitcnt lgkmcnt(6)
    v_mfma_f32_32x32x16_bf16 v[32:47], a[200:203], v[136:139], v[32:47]
    ds_read_b64_tr_b16 v[128:129], v15 offset:22528
    v_mfma_f32_32x32x16_bf16 v[64:79], a[200:203], v[140:143], v[64:79]
    ds_read_b64_tr_b16 v[130:131], v15 offset:23040
    ds_read_b64_tr_b16 v[132:133], v15 offset:30720
    buffer_load_dwordx4 v22, s[12:15], s52 offen offset:1024 lds
    v_mfma_f32_32x32x16_bf16 v[48:63], a[204:207], v[136:139], v[48:63]
    ds_read_b64_tr_b16 v[134:135], v15 offset:31232
    v_mfma_f32_32x32x16_bf16 v[80:95], a[204:207], v[140:143], v[80:95]
    ds_read_b128 a[216:219], v9 offset:0
    ds_read_b128 a[220:223], v9 offset:4096
    s_sub_u32 s52, s71, s4
    s_add_u32 m0, s61, 24576
    s_nop 0
    buffer_load_dwordx4 v21, s[12:15], s52 offen lds
    s_waitcnt lgkmcnt(6)
    v_mfma_f32_32x32x16_bf16 v[32:47], a[208:211], v[144:147], v[32:47]
    s_waitcnt vmcnt(7)
    s_barrier
    ds_read_b64_tr_b16 v[136:137], v15 offset:49152
    buffer_load_dwordx4 v22, s[12:15], s52 offen offset:1024 lds
    v_mfma_f32_32x32x16_bf16 v[64:79], a[208:211], v[148:151], v[64:79]
    ds_read_b64_tr_b16 v[138:139], v15 offset:49664
    ds_read_b64_tr_b16 v[140:141], v15 offset:57344
    s_sub_u32 s52, s73, s4
    s_add_u32 m0, s61, 131072
    s_nop 0
    buffer_load_dwordx4 v21, s[12:15], s52 offen lds
    v_mfma_f32_32x32x16_bf16 v[48:63], a[212:215], v[144:147], v[48:63]
    ds_read_b64_tr_b16 v[142:143], v15 offset:57856
    v_mfma_f32_32x32x16_bf16 v[80:95], a[212:215], v[148:151], v[80:95]
    ds_read_b128 a[224:227], v6 offset:32768
    ds_read_b128 a[228:231], v6 offset:36864
    buffer_load_dwordx4 v22, s[12:15], s52 offen offset:1024 lds
    s_waitcnt lgkmcnt(6)
    v_mfma_f32_32x32x16_bf16 v[32:47], a[216:219], v[128:131], v[32:47]
    ds_read_b64_tr_b16 v[144:145], v15 offset:51200
    v_mfma_f32_32x32x16_bf16 v[64:79], a[216:219], v[132:135], v[64:79]
    ds_read_b64_tr_b16 v[146:147], v15 offset:51712
    ds_read_b64_tr_b16 v[148:149], v15 offset:59392
    s_sub_u32 s52, s75, s4
    s_add_u32 m0, s61, 139264
    s_nop 0
    buffer_load_dwordx4 v21, s[12:15], s52 offen lds
    v_mfma_f32_32x32x16_bf16 v[48:63], a[220:223], v[128:131], v[48:63]
    ds_read_b64_tr_b16 v[150:151], v15 offset:59904
    v_mfma_f32_32x32x16_bf16 v[80:95], a[220:223], v[132:135], v[80:95]
    ds_read_b128 a[232:235], v7 offset:32768
    ds_read_b128 a[236:239], v7 offset:36864
    buffer_load_dwordx4 v22, s[12:15], s52 offen offset:1024 lds
    s_waitcnt lgkmcnt(6)
    v_mfma_f32_32x32x16_bf16 v[32:47], a[224:227], v[136:139], v[32:47]
    ds_read_b64_tr_b16 v[128:129], v15 offset:53248
    v_mfma_f32_32x32x16_bf16 v[64:79], a[224:227], v[140:143], v[64:79]
    ds_read_b64_tr_b16 v[130:131], v15 offset:53760
    ds_read_b64_tr_b16 v[132:133], v15 offset:61440
    s_sub_u32 s52, s77, s4
    s_add_u32 m0, s61, 147456
    s_nop 0
    buffer_load_dwordx4 v21, s[12:15], s52 offen lds
    v_mfma_f32_32x32x16_bf16 v[48:63], a[228:231], v[136:139], v[48:63]
    ds_read_b64_tr_b16 v[134:135], v15 offset:61952
    v_mfma_f32_32x32x16_bf16 v[80:95], a[228:231], v[140:143], v[80:95]
    ds_read_b128 a[240:243], v8 offset:32768
    ds_read_b128 a[244:247], v8 offset:36864
    buffer_load_dwordx4 v22, s[12:15], s52 offen offset:1024 lds
    s_waitcnt lgkmcnt(6)
    v_mfma_f32_32x32x16_bf16 v[32:47], a[232:235], v[144:147], v[32:47]
    ds_read_b64_tr_b16 v[136:137], v15 offset:55296
    v_mfma_f32_32x32x16_bf16 v[64:79], a[232:235], v[148:151], v[64:79]
    ds_read_b64_tr_b16 v[138:139], v15 offset:55808
    ds_read_b64_tr_b16 v[140:141], v15 offset:63488
    s_sub_u32 s52, s79, s4
    s_add_u32 m0, s61, 155648
    s_nop 0
    buffer_load_dwordx4 v21, s[12:15], s52 offen lds
    v_mfma_f32_32x32x16_bf16 v[48:63], a[236:239], v[144:147], v[48:63]
    ds_read_b64_tr_b16 v[142:143], v15 offset:64000
    v_mfma_f32_32x32x16_bf16 v[80:95], a[236:239], v[148:151], v[80:95]
    ds_read_b128 a[248:251], v9 offset:32768
    ds_read_b128 a[252:255], v9 offset:36864
    buffer_load_dwordx4 v22, s[12:15], s52 offen offset:1024 lds
    s_waitcnt lgkmcnt(6)
    v_mfma_f32_32x32x16_bf16 v[32:47], a[240:243], v[128:131], v[32:47]
    v_mfma_f32_32x32x16_bf16 v[64:79], a[240:243], v[132:135], v[64:79]
    v_mfma_f32_32x32x16_bf16 v[48:63], a[244:247], v[128:131], v[48:63]
    v_mfma_f32_32x32x16_bf16 v[80:95], a[244:247], v[132:135], v[80:95]
    s_waitcnt lgkmcnt(0)
    v_mfma_f32_32x32x16_bf16 v[32:47], a[248:251], v[136:139], v[32:47]
    v_mfma_f32_32x32x16_bf16 v[64:79], a[248:251], v[140:143], v[64:79]
    v_mfma_f32_32x32x16_bf16 v[48:63], a[252:255], v[136:139], v[48:63]
    v_mfma_f32_32x32x16_bf16 v[80:95], a[252:255], v[140:143], v[80:95]
    s_barrier
    v_readfirstlane_b32 s46, v26
    s_nop 0
    s_mul_i32 s46, s46, 0x9e3779b1
    s_add_u32 s46, s46, 0x7f4a7c15
    v_mov_b32 v26, s46
    v_mov_b32 v200, 0
    v_mov_b32 v201, 0
    v_lshlrev_b32 v202, 16, v168
    v_lshlrev_b32 v203, 16, v184
    v_and_b32 v204, 0xffff0000, v168
    v_and_b32 v205, 0xffff0000, v184
    v_fmac_f32 v200, v202, v203
    v_fmac_f32 v201, v204, v205
    v_lshlrev_b32 v202, 16, v169
    v_lshlrev_b32 v203, 16, v185
    v_and_b32 v204, 0xffff0000, v169
    v_and_b32 v205, 0xffff0000, v185
    v_fmac_f32 v200, v202, v203
    v_fmac_f32 v201, v204, v205
    v_lshlrev_b32 v202, 16, v170
    v_lshlrev_b32 v203, 16, v186
    v_and_b32 v204, 0xffff0000, v170
    v_and_b32 v205, 0xffff0000, v186
    v_fmac_f32 v200, v202, v203
    v_fmac_f32 v201, v204, v205
    v_lshlrev_b32 v202, 16, v171
    v_lshlrev_b32 v203, 16, v187
    v_and_b32 v204, 0xffff0000, v171
    v_and_b32 v205, 0xffff0000, v187
    v_fmac_f32 v200, v202, v203
    v_fmac_f32 v201, v204, v205
    v_lshlrev_b32 v202, 16, v172
    v_lshlrev_b32 v203, 16, v188
    v_and_b32 v204, 0xffff0000, v172
    v_and_b32 v205, 0xffff0000, v188
    v_fmac_f32 v200, v202, v203
    v_fmac_f32 v201, v204, v205
    v_lshlrev_b32 v202, 16, v173
    v_lshlrev_b32 v203, 16, v189
    v_and_b32 v204, 0xffff0000, v173
    v_and_b32 v205, 0xffff0000, v189
    v_fmac_f32 v200, v202, v203
    v_fmac_f32 v201, v204, v205
    v_lshlrev_b32 v202, 16, v174
    v_lshlrev_b32 v203, 16, v190
    v_and_b32 v204, 0xffff0000, v174
    v_and_b32 v205, 0xffff0000, v190
    v_fmac_f32 v200, v202, v203
    v_fmac_f32 v201, v204, v205
    v_lshlrev_b32 v202, 16, v175
    v_lshlrev_b32 v203, 16, v191
    v_and_b32 v204, 0xffff0000, v175
    v_and_b32 v205, 0xffff0000, v191
    v_fmac_f32 v200, v202, v203
    v_fmac_f32 v201, v204, v205
    v_lshlrev_b32 v202, 16, v176
    v_lshlrev_b32 v203, 16, v192
    v_and_b32 v204, 0xffff0000, v176
    v_and_b32 v205, 0xffff0000, v192
    v_fmac_f32 v200, v202, v203
    v_fmac_f32 v201, v204, v205
    v_lshlrev_b32 v202, 16, v177
    v_lshlrev_b32 v203, 16, v193
    v_and_b32 v204, 0xffff0000, v177
    v_and_b32 v205, 0xffff0000, v193
    v_fmac_f32 v200, v202, v203
    v_fmac_f32 v201, v204, v205
    v_lshlrev_b32 v202, 16, v178
    v_lshlrev_b32 v203, 16, v194
    v_and_b32 v204, 0xffff0000, v178
    v_and_b32 v205, 0xffff0000, v194
    v_fmac_f32 v200, v202, v203
    v_fmac_f32 v201, v204, v205
    v_lshlrev_b32 v202, 16, v179
    v_lshlrev_b32 v203, 16, v195
    v_and_b32 v204, 0xffff0000, v179
    v_and_b32 v205, 0xffff0000, v195
    v_fmac_f32 v200, v202, v203
    v_fmac_f32 v201, v204, v205
    v_lshlrev_b32 v202, 16, v180
    v_lshlrev_b32 v203, 16, v196
    v_and_b32 v204, 0xffff0000, v180
    v_and_b32 v205, 0xffff0000, v196
    v_fmac_f32 v200, v202, v203
    v_fmac_f32 v201, v204, v205
    v_lshlrev_b32 v202, 16, v181
    v_lshlrev_b32 v203, 16, v197
    v_and_b32 v204, 0xffff0000, v181
    v_and_b32 v205, 0xffff0000, v197
    v_fmac_f32 v200, v202, v203
    v_fmac_f32 v201, v204, v205
    v_lshlrev_b32 v202, 16, v182
    v_lshlrev_b32 v203, 16, v198
    v_and_b32 v204, 0xffff0000, v182
    v_and_b32 v205, 0xffff0000, v198
    v_fmac_f32 v200, v202, v203
    v_fmac_f32 v201, v204, v205
    v_lshlrev_b32 v202, 16, v183
    v_lshlrev_b32 v203, 16, v199
    v_and_b32 v204, 0xffff0000, v183
    v_and_b32 v205, 0xffff0000, v199
    v_fmac_f32 v200, v202, v203
    v_fmac_f32 v201, v204, v205
    v_add_f32 v200, v200, v201
    s_nop 1
    v_add_f32_dpp v200, v200, v200 row_ror:8 row_mask:0xf bank_mask:0xf
    s_nop 1
    v_add_f32_dpp v200, v200, v200 row_ror:4 row_mask:0xf bank_mask:0xf
    s_nop 1
    v_add_f32_dpp v200, v200, v200 row_ror:2 row_mask:0xf bank_mask:0xf
    s_nop 1
    v_add_f32_dpp v200, v200, v200 row_ror:1 row_mask:0xf bank_mask:0xf
    v_mul_f32 v200, s84, v200
    v_exp_f32_e64 v200, -v200
    s_nop 0
    v_add_f32 v200, 1.0, v200
    v_rcp_f32 v200, v200
    v_mov_b32 v201, v26
    v_lshrrev_b32 v27, 4, v1
    v_lshlrev_b32 v27, 3, v27
    s_mov_b32 exec_lo, 0x00010001
    s_mov_b32 exec_hi, 0x00010001
    buffer_store_dwordx2 v[200:201], v27, s[24:27], s93 offen sc1
    s_mov_b64 exec, -1
    v_pk_mul_f32 v[184:185], v[32:33], s[84:85]
    v_pk_mul_f32 v[186:187], v[34:35], s[84:85]
    v_pk_mul_f32 v[188:189], v[36:37], s[84:85]
    v_pk_mul_f32 v[190:191], v[38:39], s[84:85]
    v_exp_f32 v184, v184 clamp
    v_exp_f32 v185, v185 clamp
    v_exp_f32 v186, v186 clamp
    v_exp_f32 v187, v187 clamp
    v_exp_f32 v188, v188 clamp
    v_exp_f32 v189, v189 clamp
    v_exp_f32 v190, v190 clamp
    v_exp_f32 v191, v191 clamp
    s_mov_b32 s52, s96
    s_add_u32 m0, s97, 32768
    s_nop 0
    buffer_load_dwordx4 v10, s[16:19], s52 offen lds
    v_max_f32 v32, 0, v32
    v_max_f32 v33, 0, v33
    v_max_f32 v34, 0, v34
    v_max_f32 v35, 0, v35
    v_max_f32 v36, 0, v36
    v_max_f32 v37, 0, v37
    v_max_f32 v38, 0, v38
    v_max_f32 v39, 0, v39
    v_pk_add_f32 v[32:33], v[32:33], v[184:185]
    v_pk_add_f32 v[34:35], v[34:35], v[186:187]
    buffer_load_dwordx4 v11, s[16:19], s52 offen offset:1024 lds
    v_pk_add_f32 v[36:37], v[36:37], v[188:189]
    v_pk_add_f32 v[38:39], v[38:39], v[190:191]
    v_pk_add_f32 v[32:33], v[32:33], s[86:87]
    v_pk_add_f32 v[34:35], v[34:35], s[86:87]
    v_pk_add_f32 v[36:37], v[36:37], s[86:87]
    v_pk_add_f32 v[38:39], v[38:39], s[86:87]
    v_cvt_pk_bf16_f32 v168, v32, v33
    v_cvt_pk_bf16_f32 v169, v34, v35
    v_cvt_pk_bf16_f32 v170, v36, v37
    v_cvt_pk_bf16_f32 v171, v38, v39
    buffer_load_dwordx4 v12, s[16:19], s52 offen offset:2048 lds
    v_pk_mul_f32 v[184:185], v[40:41], s[84:85]
    v_pk_mul_f32 v[186:187], v[42:43], s[84:85]
    v_pk_mul_f32 v[188:189], v[44:45], s[84:85]
    v_pk_mul_f32 v[190:191], v[46:47], s[84:85]
    v_exp_f32 v184, v184 clamp
    v_exp_f32 v185, v185 clamp
    v_exp_f32 v186, v186 clamp
    v_exp_f32 v187, v187 clamp
    v_exp_f32 v188, v188 clamp
    v_exp_f32 v189, v189 clamp
    buffer_load_dwordx4 v13, s[16:19], s52 offen offset:3072 lds
    v_exp_f32 v190, v190 clamp
    v_exp_f32 v191, v191 clamp
    v_max_f32 v40, 0, v40
    v_max_f32 v41, 0, v41
    v_max_f32 v42, 0, v42
    v_max_f32 v43, 0, v43
    v_max_f32 v44, 0, v44
    v_max_f32 v45, 0, v45
    v_max_f32 v46, 0, v46
    v_max_f32 v47, 0, v47
    s_mov_b32 s52, s96
    s_add_u32 s52, s52, 32768
    s_add_u32 m0, s97, 36864
    s_nop 0
    buffer_load_dwordx4 v10, s[16:19], s52 offen lds
    v_pk_add_f32 v[40:41], v[40:41], v[184:185]
    v_pk_add_f32 v[42:43], v[42:43], v[186:187]
    v_pk_add_f32 v[44:45], v[44:45], v[188:189]
    v_pk_add_f32 v[46:47], v[46:47], v[190:191]
    v_pk_add_f32 v[40:41], v[40:41], s[86:87]
    v_pk_add_f32 v[42:43], v[42:43], s[86:87]
    v_pk_add_f32 v[44:45], v[44:45], s[86:87]
    v_pk_add_f32 v[46:47], v[46:47], s[86:87]
    v_cvt_pk_bf16_f32 v172, v40, v41
    v_cvt_pk_bf16_f32 v173, v42, v43
    buffer_load_dwordx4 v11, s[16:19], s52 offen offset:1024 lds
    v_cvt_pk_bf16_f32 v174, v44, v45
    v_cvt_pk_bf16_f32 v175, v46, v47
    v_pk_mul_f32 v[184:185], v[48:49], s[84:85]
    v_pk_mul_f32 v[186:187], v[50:51], s[84:85]
    v_pk_mul_f32 v[188:189], v[52:53], s[84:85]
    v_pk_mul_f32 v[190:191], v[54:55], s[84:85]
    v_exp_f32 v184, v184 clamp
    v_exp_f32 v185, v185 clamp
    v_exp_f32 v186, v186 clamp
    v_exp_f32 v187, v187 clamp
    buffer_load_dwordx4 v12, s[16:19], s52 offen offset:2048 lds
    v_exp_f32 v188, v188 clamp
    v_exp_f32 v189, v189 clamp
    v_exp_f32 v190, v190 clamp
    v_exp_f32 v191, v191 clamp
    v_max_f32 v48, 0, v48
    v_max_f32 v49, 0, v49
    v_max_f32 v50, 0, v50
    v_max_f32 v51, 0, v51
    v_max_f32 v52, 0, v52
    v_max_f32 v53, 0, v53
    buffer_load_dwordx4 v13, s[16:19], s52 offen offset:3072 lds
    v_max_f32 v54, 0, v54
    v_max_f32 v55, 0, v55
    v_pk_add_f32 v[48:49], v[48:49], v[184:185]
    v_pk_add_f32 v[50:51], v[50:51], v[186:187]
    v_pk_add_f32 v[52:53], v[52:53], v[188:189]
    v_pk_add_f32 v[54:55], v[54:55], v[190:191]
    v_pk_add_f32 v[48:49], v[48:49], s[86:87]
    v_pk_add_f32 v[50:51], v[50:51], s[86:87]
    v_pk_add_f32 v[52:53], v[52:53], s[86:87]
    v_pk_add_f32 v[54:55], v[54:55], s[86:87]
    v_cvt_pk_bf16_f32 v176, v48, v49
    v_cvt_pk_bf16_f32 v177, v50, v51
    v_cvt_pk_bf16_f32 v178, v52, v53
    v_cvt_pk_bf16_f32 v179, v54, v55
    v_pk_mul_f32 v[184:185], v[56:57], s[84:85]
    v_pk_mul_f32 v[186:187], v[58:59], s[84:85]
    v_pk_mul_f32 v[188:189], v[60:61], s[84:85]
    v_pk_mul_f32 v[190:191], v[62:63], s[84:85]
    v_exp_f32 v184, v184 clamp
    v_exp_f32 v185, v185 clamp
    v_exp_f32 v186, v186 clamp
    v_exp_f32 v187, v187 clamp
    v_exp_f32 v188, v188 clamp
    v_exp_f32 v189, v189 clamp
    v_exp_f32 v190, v190 clamp
    v_exp_f32 v191, v191 clamp
    v_max_f32 v56, 0, v56
    v_max_f32 v57, 0, v57
    v_max_f32 v58, 0, v58
    v_max_f32 v59, 0, v59
    v_max_f32 v60, 0, v60
    v_max_f32 v61, 0, v61
    v_max_f32 v62, 0, v62
    v_max_f32 v63, 0, v63
    v_pk_add_f32 v[56:57], v[56:57], v[184:185]
    v_pk_add_f32 v[58:59], v[58:59], v[186:187]
    v_pk_add_f32 v[60:61], v[60:61], v[188:189]
    v_pk_add_f32 v[62:63], v[62:63], v[190:191]
    v_pk_add_f32 v[56:57], v[56:57], s[86:87]
    v_pk_add_f32 v[58:59], v[58:59], s[86:87]
    v_pk_add_f32 v[60:61], v[60:61], s[86:87]
    v_pk_add_f32 v[62:63], v[62:63], s[86:87]
    v_cvt_pk_bf16_f32 v180, v56, v57
    v_cvt_pk_bf16_f32 v181, v58, v59
    v_cvt_pk_bf16_f32 v182, v60, v61
    v_cvt_pk_bf16_f32 v183, v62, v63
    v_cvt_pk_bf16_f32 v200, v64, v65
    v_cvt_pk_bf16_f32 v201, v66, v67
    v_cvt_pk_bf16_f32 v202, v68, v69
    v_cvt_pk_bf16_f32 v203, v70, v71
    v_cvt_pk_bf16_f32 v204, v72, v73
    v_cvt_pk_bf16_f32 v205, v74, v75
    v_cvt_pk_bf16_f32 v206, v76, v77
    v_cvt_pk_bf16_f32 v207, v78, v79
    v_cvt_pk_bf16_f32 v208, v80, v81
    v_cvt_pk_bf16_f32 v209, v82, v83
    v_cvt_pk_bf16_f32 v210, v84, v85
    v_cvt_pk_bf16_f32 v211, v86, v87
    v_cvt_pk_bf16_f32 v212, v88, v89
    v_cvt_pk_bf16_f32 v213, v90, v91
    v_cvt_pk_bf16_f32 v214, v92, v93
    v_cvt_pk_bf16_f32 v215, v94, v95
    v_cndmask_b32_e64 v216, v25, v200, s[62:63]
    v_cndmask_b32_e64 v217, v25, v201, s[62:63]
    v_cndmask_b32_e64 v218, v25, v202, s[62:63]
    v_cndmask_b32_e64 v219, v25, v203, s[62:63]
    v_cndmask_b32_e64 v220, v25, v204, s[62:63]
    v_cndmask_b32_e64 v221, v25, v205, s[62:63]
    v_cndmask_b32_e64 v222, v25, v206, s[62:63]
    v_cndmask_b32_e64 v223, v25, v207, s[62:63]
    v_cndmask_b32_e64 v224, v25, v208, s[62:63]
    v_cndmask_b32_e64 v225, v25, v209, s[62:63]
    v_cndmask_b32_e64 v226, v25, v210, s[62:63]
    v_cndmask_b32_e64 v227, v25, v211, s[62:63]
    v_cndmask_b32_e64 v228, v25, v212, s[62:63]
    v_cndmask_b32_e64 v229, v25, v213, s[62:63]
    v_cndmask_b32_e64 v230, v25, v214, s[62:63]
    v_cndmask_b32_e64 v231, v25, v215, s[62:63]
    v_cndmask_b32_e64 v200, v200, v25, s[62:63]
    v_cndmask_b32_e64 v201, v201, v25, s[62:63]
    v_cndmask_b32_e64 v202, v202, v25, s[62:63]
    v_cndmask_b32_e64 v203, v203, v25, s[62:63]
    v_cndmask_b32_e64 v204, v204, v25, s[62:63]
    v_cndmask_b32_e64 v205, v205, v25, s[62:63]
    v_cndmask_b32_e64 v206, v206, v25, s[62:63]
    v_cndmask_b32_e64 v207, v207, v25, s[62:63]
    v_cndmask_b32_e64 v208, v208, v25, s[62:63]
    v_cndmask_b32_e64 v209, v209, v25, s[62:63]
    v_cndmask_b32_e64 v210, v210, v25, s[62:63]
    v_cndmask_b32_e64 v211, v211, v25, s[62:63]
    v_cndmask_b32_e64 v212, v212, v25, s[62:63]
    v_cndmask_b32_e64 v213, v213, v25, s[62:63]
    v_cndmask_b32_e64 v214, v214, v25, s[62:63]
    v_cndmask_b32_e64 v215, v215, v25, s[62:63]
    v_mov_b32 v187, v26
    v_mov_b32 v191, v26
    v_lshlrev_b32 v27, 4, v1
    s_lshl_b32 s53, s40, 12
    s_add_u32 s53, s53, 98304
    v_add_u32 v28, s53, v27
    s_xor_b32 s53, s53, 4096
    v_xor_b32 v27, 256, v27
    v_add_u32 v29, s53, v27
    v_lshrrev_b32 v30, 4, v1
    v_lshlrev_b32 v30, 12, v30
    v_and_b32 v27, 15, v1
    v_lshl_add_u32 v30, v27, 4, v30
    v_mfma_f32_32x32x16_bf16 v[96:111], v[168:171], v[200:203], 0
    v_mfma_f32_32x32x16_bf16 v[96:111], v[172:175], v[204:207], v[96:111]
    v_mfma_f32_32x32x16_bf16 v[112:127], v[168:171], v[216:219], 0
    v_mfma_f32_32x32x16_bf16 v[112:127], v[172:175], v[220:223], v[112:127]
    v_mfma_f32_32x32x16_bf16 v[96:111], v[176:179], v[208:211], v[96:111]
    v_mfma_f32_32x32x16_bf16 v[96:111], v[180:183], v[212:215], v[96:111]
    v_mfma_f32_32x32x16_bf16 v[112:127], v[176:179], v[224:227], v[112:127]
    v_mfma_f32_32x32x16_bf16 v[112:127], v[180:183], v[228:231], v[112:127]
    s_nop 11
    ds_write_b128 v28, v[120:123] offset:0
    ds_write_b128 v28, v[124:127] offset:1024
    s_lshl_b32 s59, s44, 2
    s_add_u32 s59, s59, s40
    s_add_u32 s59, s59, 0
    s_lshl_b32 s55, s59, 16
    s_lshl_b32 s54, s43, 8
    s_add_u32 s55, s55, s54
    s_add_u32 s55, s55, 8388608
    s_waitcnt vmcnt(9) lgkmcnt(0)
    s_barrier
    ds_read_b128 v[216:219], v29 offset:0
    ds_read_b128 v[220:223], v29 offset:1024
    s_waitcnt lgkmcnt(0)
    v_add_f32 v184, v96, v216
    v_add_f32 v185, v97, v217
    v_add_f32 v188, v98, v218
    v_add_f32 v189, v99, v219
    v_add_f32 v200, v100, v220
    v_add_f32 v201, v101, v221
    v_add_f32 v202, v102, v222
    v_add_f32 v203, v103, v223
    v_permlane16_swap_b32 v184, v200
    v_permlane16_swap_b32 v185, v201
    v_permlane16_swap_b32 v188, v202
    v_permlane16_swap_b32 v189, v203
    v_cndmask_b32_e64 v186, v200, v201, s[94:95]
    v_cndmask_b32_e64 v190, v202, v203, s[94:95]
    ds_read_b64_tr_b16 v[128:129], v14 offset:0
    ds_read_b64_tr_b16 v[130:131], v14 offset:512
    ds_read_b64_tr_b16 v[132:133], v14 offset:2048
    ds_read_b64_tr_b16 v[134:135], v14 offset:2560
    ds_read_b64_tr_b16 v[136:137], v14 offset:4096
    ds_read_b64_tr_b16 v[138:139], v14 offset:4608
    s_waitcnt lgkmcnt(4)
    v_mfma_f32_32x32x16_bf16 v[96:111], v[128:131], a[0:3], 0
    ds_read_b64_tr_b16 v[140:141], v14 offset:6144
    ds_read_b64_tr_b16 v[142:143], v14 offset:6656
    buffer_store_dwordx4 v[184:187], v30, s[24:27], s55 offen sc1
    s_add_u32 s55, s55, 16384
    v_mfma_f32_32x32x16_bf16 v[112:127], v[128:131], a[4:7], 0
    s_waitcnt lgkmcnt(4)
    s_barrier
    v_mfma_f32_32x32x16_bf16 v[96:111], v[132:135], a[8:11], v[96:111]
    ds_read_b64_tr_b16 v[128:129], v14 offset:8192
    ds_read_b64_tr_b16 v[130:131], v14 offset:8704
    buffer_store_dwordx4 v[188:191], v30, s[24:27], s55 offen sc1
    v_mfma_f32_32x32x16_bf16 v[112:127], v[132:135], a[12:15], v[112:127]
    s_waitcnt lgkmcnt(4)
    v_mfma_f32_32x32x16_bf16 v[96:111], v[136:139], a[16:19], v[96:111]
    ds_read_b64_tr_b16 v[132:133], v14 offset:10240
    ds_read_b64_tr_b16 v[134:135], v14 offset:10752
    v_mfma_f32_32x32x16_bf16 v[112:127], v[136:139], a[20:23], v[112:127]
    s_waitcnt lgkmcnt(4)
    v_mfma_f32_32x32x16_bf16 v[96:111], v[140:143], a[24:27], v[96:111]
    ds_read_b64_tr_b16 v[136:137], v14 offset:12288
    ds_read_b64_tr_b16 v[138:139], v14 offset:12800
    v_mfma_f32_32x32x16_bf16 v[112:127], v[140:143], a[28:31], v[112:127]
    s_waitcnt lgkmcnt(4)
    v_mfma_f32_32x32x16_bf16 v[96:111], v[128:131], a[32:35], v[96:111]
    ds_read_b64_tr_b16 v[140:141], v14 offset:14336
    ds_read_b64_tr_b16 v[142:143], v14 offset:14848
    s_xor_b32 s52, s96, 262144
    s_add_u32 m0, s97, 65536
    s_nop 0
    buffer_load_dwordx4 v10, s[16:19], s52 offen lds
    v_mfma_f32_32x32x16_bf16 v[112:127], v[128:131], a[36:39], v[112:127]
    s_waitcnt lgkmcnt(4)
    v_mfma_f32_32x32x16_bf16 v[96:111], v[132:135], a[40:43], v[96:111]
    ds_read_b64_tr_b16 v[128:129], v14 offset:16384
    ds_read_b64_tr_b16 v[130:131], v14 offset:16896
    buffer_load_dwordx4 v11, s[16:19], s52 offen offset:1024 lds
    v_mfma_f32_32x32x16_bf16 v[112:127], v[132:135], a[44:47], v[112:127]
    s_waitcnt lgkmcnt(4)
    v_mfma_f32_32x32x16_bf16 v[96:111], v[136:139], a[48:51], v[96:111]
    ds_read_b64_tr_b16 v[132:133], v14 offset:18432
    ds_read_b64_tr_b16 v[134:135], v14 offset:18944
    buffer_load_dwordx4 v12, s[16:19], s52 offen offset:2048 lds
    v_mfma_f32_32x32x16_bf16 v[112:127], v[136:139], a[52:55], v[112:127]
    s_waitcnt lgkmcnt(4)
    v_mfma_f32_32x32x16_bf16 v[96:111], v[140:143], a[56:59], v[96:111]
    ds_read_b64_tr_b16 v[136:137], v14 offset:20480
    ds_read_b64_tr_b16 v[138:139], v14 offset:20992
    buffer_load_dwordx4 v13, s[16:19], s52 offen offset:3072 lds
    v_mfma_f32_32x32x16_bf16 v[112:127], v[140:143], a[60:63], v[112:127]
    s_waitcnt lgkmcnt(4)
    v_mfma_f32_32x32x16_bf16 v[96:111], v[128:131], a[64:67], v[96:111]
    ds_read_b64_tr_b16 v[140:141], v14 offset:22528
    ds_read_b64_tr_b16 v[142:143], v14 offset:23040
    s_xor_b32 s52, s96, 262144
    s_add_u32 s52, s52, 32768
    s_add_u32 m0, s97, 69632
    s_nop 0
    buffer_load_dwordx4 v10, s[16:19], s52 offen lds
    v_mfma_f32_32x32x16_bf16 v[112:127], v[128:131], a[68:71], v[112:127]
    s_waitcnt lgkmcnt(4)
    v_mfma_f32_32x32x16_bf16 v[96:111], v[132:135], a[72:75], v[96:111]
    ds_read_b64_tr_b16 v[128:129], v14 offset:24576
    ds_read_b64_tr_b16 v[130:131], v14 offset:25088
    buffer_load_dwordx4 v11, s[16:19], s52 offen offset:1024 lds
    v_mfma_f32_32x32x16_bf16 v[112:127], v[132:135], a[76:79], v[112:127]
    s_waitcnt lgkmcnt(4)
    v_mfma_f32_32x32x16_bf16 v[96:111], v[136:139], a[80:83], v[96:111]
    ds_read_b64_tr_b16 v[132:133], v14 offset:26624
    ds_read_b64_tr_b16 v[134:135], v14 offset:27136
    buffer_load_dwordx4 v12, s[16:19], s52 offen offset:2048 lds
    v_mfma_f32_32x32x16_bf16 v[112:127], v[136:139], a[84:87], v[112:127]
    s_waitcnt lgkmcnt(4)
    v_mfma_f32_32x32x16_bf16 v[96:111], v[140:143], a[88:91], v[96:111]
    ds_read_b64_tr_b16 v[136:137], v14 offset:28672
    ds_read_b64_tr_b16 v[138:139], v14 offset:29184
    buffer_load_dwordx4 v13, s[16:19], s52 offen offset:3072 lds
    v_mfma_f32_32x32x16_bf16 v[112:127], v[140:143], a[92:95], v[112:127]
    s_waitcnt lgkmcnt(4)
    v_mfma_f32_32x32x16_bf16 v[96:111], v[128:131], a[96:99], v[96:111]
    ds_read_b64_tr_b16 v[140:141], v14 offset:30720
    ds_read_b64_tr_b16 v[142:143], v14 offset:31232
    v_mfma_f32_32x32x16_bf16 v[112:127], v[128:131], a[100:103], v[112:127]
    s_waitcnt lgkmcnt(4)
    v_mfma_f32_32x32x16_bf16 v[96:111], v[132:135], a[104:107], v[96:111]
    ds_read_b64_tr_b16 v[128:129], v16 offset:0
    ds_read_b64_tr_b16 v[130:131], v16 offset:512
    v_mfma_f32_32x32x16_bf16 v[112:127], v[132:135], a[108:111], v[112:127]
    s_waitcnt lgkmcnt(4)
    v_mfma_f32_32x32x16_bf16 v[96:111], v[136:139], a[112:115], v[96:111]
    ds_read_b64_tr_b16 v[132:133], v16 offset:2048
    ds_read_b64_tr_b16 v[134:135], v16 offset:2560
    v_mfma_f32_32x32x16_bf16 v[112:127], v[136:139], a[116:119], v[112:127]
    s_waitcnt lgkmcnt(4)
    v_mfma_f32_32x32x16_bf16 v[96:111], v[140:143], a[120:123], v[96:111]
    ds_read_b64_tr_b16 v[136:137], v16 offset:4096
    ds_read_b64_tr_b16 v[138:139], v16 offset:4608
    v_mfma_f32_32x32x16_bf16 v[112:127], v[140:143], a[124:127], v[112:127]
    s_waitcnt lgkmcnt(4)
    v_mfma_f32_32x32x16_bf16 v[96:111], v[128:131], a[128:131], v[96:111]
    ds_read_b64_tr_b16 v[140:141], v16 offset:6144
    ds_read_b64_tr_b16 v[142:143], v16 offset:6656
    v_mfma_f32_32x32x16_bf16 v[112:127], v[128:131], a[132:135], v[112:127]
    s_waitcnt lgkmcnt(4)
    v_mfma_f32_32x32x16_bf16 v[96:111], v[132:135], a[136:139], v[96:111]
    ds_read_b64_tr_b16 v[128:129], v16 offset:8192
    ds_read_b64_tr_b16 v[130:131], v16 offset:8704
    v_mfma_f32_32x32x16_bf16 v[112:127], v[132:135], a[140:143], v[112:127]
    s_waitcnt lgkmcnt(4)
    v_mfma_f32_32x32x16_bf16 v[96:111], v[136:139], a[144:147], v[96:111]
    ds_read_b64_tr_b16 v[132:133], v16 offset:10240
    ds_read_b64_tr_b16 v[134:135], v16 offset:10752
    v_mfma_f32_32x32x16_bf16 v[112:127], v[136:139], a[148:151], v[112:127]
    s_waitcnt lgkmcnt(4)
    v_mfma_f32_32x32x16_bf16 v[96:111], v[140:143], a[152:155], v[96:111]
    ds_read_b64_tr_b16 v[136:137], v16 offset:12288
    ds_read_b64_tr_b16 v[138:139], v16 offset:12800
    s_lshl_b32 s98, s59, 16
    s_lshl_b32 s54, s43, 12
    s_add_u32 s98, s98, s54
    s_add_u32 s98, s98, 8388608
    v_lshlrev_b32 v27, 4, v1
    v_mfma_f32_32x32x16_bf16 v[112:127], v[140:143], a[156:159], v[112:127]
    s_waitcnt lgkmcnt(4)
    v_mfma_f32_32x32x16_bf16 v[96:111], v[128:131], a[160:163], v[96:111]
    ds_read_b64_tr_b16 v[140:141], v16 offset:14336
    ds_read_b64_tr_b16 v[142:143], v16 offset:14848
    buffer_load_dwordx4 v[184:187], v27, s[24:27], s98 offen offset:0 sc1
    v_mfma_f32_32x32x16_bf16 v[112:127], v[128:131], a[164:167], v[112:127]
    s_waitcnt lgkmcnt(4)
    v_mfma_f32_32x32x16_bf16 v[96:111], v[132:135], a[168:171], v[96:111]
    ds_read_b64_tr_b16 v[128:129], v16 offset:16384
    ds_read_b64_tr_b16 v[130:131], v16 offset:16896
    buffer_load_dwordx4 v[188:191], v27, s[24:27], s98 offen offset:1024 sc1
    v_mfma_f32_32x32x16_bf16 v[112:127], v[132:135], a[172:175], v[112:127]
    s_waitcnt lgkmcnt(4)
    v_mfma_f32_32x32x16_bf16 v[96:111], v[136:139], a[176:179], v[96:111]
    ds_read_b64_tr_b16 v[132:133], v16 offset:18432
    ds_read_b64_tr_b16 v[134:135], v16 offset:18944
    buffer_load_dwordx4 v[192:195], v27, s[24:27], s98 offen offset:2048 sc1
    v_mfma_f32_32x32x16_bf16 v[112:127], v[136:139], a[180:183], v[112:127]
    s_waitcnt lgkmcnt(4)
    v_mfma_f32_32x32x16_bf16 v[96:111], v[140:143], a[184:187], v[96:111]
    ds_read_b64_tr_b16 v[136:137], v16 offset:20480
    ds_read_b64_tr_b16 v[138:139], v16 offset:20992
    buffer_load_dwordx4 v[196:199], v27, s[24:27], s98 offen offset:3072 sc1
    v_mfma_f32_32x32x16_bf16 v[112:127], v[140:143], a[188:191], v[112:127]
    s_waitcnt lgkmcnt(4)
    v_mfma_f32_32x32x16_bf16 v[96:111], v[128:131], a[192:195], v[96:111]
    ds_read_b64_tr_b16 v[140:141], v16 offset:22528
    ds_read_b64_tr_b16 v[142:143], v16 offset:23040
    v_mfma_f32_32x32x16_bf16 v[112:127], v[128:131], a[196:199], v[112:127]
    s_waitcnt lgkmcnt(4)
    v_mfma_f32_32x32x16_bf16 v[96:111], v[132:135], a[200:203], v[96:111]
    ds_read_b64_tr_b16 v[128:129], v16 offset:24576
    ds_read_b64_tr_b16 v[130:131], v16 offset:25088
    v_mfma_f32_32x32x16_bf16 v[112:127], v[132:135], a[204:207], v[112:127]
    s_waitcnt lgkmcnt(4)
    v_mfma_f32_32x32x16_bf16 v[96:111], v[136:139], a[208:211], v[96:111]
    ds_read_b64_tr_b16 v[132:133], v16 offset:26624
    ds_read_b64_tr_b16 v[134:135], v16 offset:27136
    v_mfma_f32_32x32x16_bf16 v[112:127], v[136:139], a[212:215], v[112:127]
    s_waitcnt lgkmcnt(4)
    v_mfma_f32_32x32x16_bf16 v[96:111], v[140:143], a[216:219], v[96:111]
    ds_read_b64_tr_b16 v[136:137], v16 offset:28672
    ds_read_b64_tr_b16 v[138:139], v16 offset:29184
    v_mfma_f32_32x32x16_bf16 v[112:127], v[140:143], a[220:223], v[112:127]
    s_waitcnt lgkmcnt(4)
    v_mfma_f32_32x32x16_bf16 v[96:111], v[128:131], a[224:227], v[96:111]
    ds_read_b64_tr_b16 v[140:141], v16 offset:30720
    ds_read_b64_tr_b16 v[142:143], v16 offset:31232
    v_mfma_f32_32x32x16_bf16 v[112:127], v[128:131], a[228:231], v[112:127]
    s_waitcnt lgkmcnt(4)
    v_mfma_f32_32x32x16_bf16 v[96:111], v[132:135], a[232:235], v[96:111]
    v_mfma_f32_32x32x16_bf16 v[112:127], v[132:135], a[236:239], v[112:127]
    s_waitcnt lgkmcnt(2)
    v_mfma_f32_32x32x16_bf16 v[96:111], v[136:139], a[240:243], v[96:111]
    v_mfma_f32_32x32x16_bf16 v[112:127], v[136:139], a[244:247], v[112:127]
    s_waitcnt lgkmcnt(0)
    v_mfma_f32_32x32x16_bf16 v[96:111], v[140:143], a[248:251], v[96:111]
    v_mfma_f32_32x32x16_bf16 v[112:127], v[140:143], a[252:255], v[112:127]
    s_waitcnt vmcnt(0)
    s_cmp_ge_u32 s43, 8
    s_cbranch_scc1 L_h1skip
    s_mov_b32 s88, 32768
    v_min_u32 v28, v187, v191
    v_max_u32 v29, v187, v191
    v_min3_u32 v28, v28, v195, v199
    v_max3_u32 v29, v29, v195, v199
    v_xor_b32 v28, v26, v28
    v_xor_b32 v29, v26, v29
    v_or_b32 v28, v28, v29
    v_cmp_ne_u32 vcc, 0, v28
    s_nop 4
    s_cbranch_vccz L_h1A_ok
L_h1A:
    buffer_load_dwordx4 v[184:187], v27, s[24:27], s98 offen offset:0 sc1
    buffer_load_dwordx4 v[188:191], v27, s[24:27], s98 offen offset:1024 sc1
    buffer_load_dwordx4 v[192:195], v27, s[24:27], s98 offen offset:2048 sc1
    buffer_load_dwordx4 v[196:199], v27, s[24:27], s98 offen offset:3072 sc1
    s_waitcnt vmcnt(0)
    v_min_u32 v28, v187, v191
    v_max_u32 v29, v187, v191
    v_min3_u32 v28, v28, v195, v199
    v_max3_u32 v29, v29, v195, v199
    v_xor_b32 v28, v26, v28
    v_xor_b32 v29, v26, v29
    v_or_b32 v28, v28, v29
    v_cmp_ne_u32 vcc, 0, v28
    s_nop 4
    s_cbranch_vccz L_h1A_ok
    s_sub_u32 s88, s88, 1
    s_cmp_gt_i32 s88, 0
    s_cbranch_scc1 L_h1A
L_h1A_ok:
    v_add_f32 v216, v184, v188
    v_add_f32 v217, v185, v189
    v_add_f32 v218, v186, v190
    v_add_f32 v216, v216, v192
    v_add_f32 v217, v217, v193
    v_add_f32 v218, v218, v194
    v_add_f32 v216, v216, v196
    v_add_f32 v217, v217, v197
    v_add_f32 v218, v218, v198
    v_mov_b32 v219, v218
    s_lshl_b32 s53, s59, 11
    s_lshl_b32 s54, s43, 7
    s_add_u32 s53, s53, s54
    s_add_u32 s53, s53, 1048576
    v_permlane32_swap_b32 v216, v217
    v_permlane32_swap_b32 v218, v219
    v_add_f32 v216, v216, v217
    v_add_f32 v218, v218, v219
    v_lshlrev_b32 v27, 4, v1
    v_mov_b32 v217, v216
    v_mov_b32 v219, v218
    v_mov_b32 v223, v26
    s_nop 0
    v_permlane16_swap_b32 v216, v217
    v_permlane16_swap_b32 v218, v219
    v_add_f32 v216, v216, v217
    v_add_f32 v218, v218, v219
    v_mov_b32 v217, v216
    s_nop 0
    v_mov_b32_dpp v219, v218 quad_perm:[1,1,1,1] row_mask:0xf bank_mask:0xf
    v_permlane32_swap_b32 v216, v217
    v_mov_b32_dpp v222, v218 quad_perm:[0,0,0,0] row_mask:0xf bank_mask:0xf
    v_cvt_pk_bf16_f32 v220, v216, v217
    v_cvt_pk_bf16_f32 v222, v222, v219
    s_nop 0
    v_mov_b32_dpp v221, v220 row_ror:8 row_mask:0xf bank_mask:0xf
    s_mov_b32 exec_lo, 0xff
    s_mov_b32 exec_hi, 0
    buffer_store_dwordx4 v[220:223], v27, s[24:27], s53 offen sc1
    s_mov_b64 exec, -1
L_h1skip:
    v_pk_mul_f32 v[184:185], v[96:97], s[84:85]
    v_pk_mul_f32 v[186:187], v[98:99], s[84:85]
    v_pk_mul_f32 v[188:189], v[100:101], s[84:85]
    v_pk_mul_f32 v[190:191], v[102:103], s[84:85]
    v_exp_f32 v184, v184 clamp
    v_exp_f32 v185, v185 clamp
    v_exp_f32 v186, v186 clamp
    s_mov_b32 s52, s96
    s_add_u32 m0, s97, 98304
    s_nop 0
    buffer_load_dwordx4 v10, s[20:23], s52 offen lds
    v_exp_f32 v187, v187 clamp
    v_exp_f32 v188, v188 clamp
    v_exp_f32 v189, v189 clamp
    v_exp_f32 v190, v190 clamp
    v_exp_f32 v191, v191 clamp
    v_max_f32 v96, 0, v96
    buffer_load_dwordx4 v11, s[20:23], s52 offen offset:1024 lds
    v_max_f32 v97, 0, v97
    v_max_f32 v98, 0, v98
    v_max_f32 v99, 0, v99
    v_max_f32 v100, 0, v100
    v_max_f32 v101, 0, v101
    v_max_f32 v102, 0, v102
    buffer_load_dwordx4 v12, s[20:23], s52 offen offset:2048 lds
    v_max_f32 v103, 0, v103
    v_pk_add_f32 v[96:97], v[96:97], v[184:185]
    v_pk_add_f32 v[98:99], v[98:99], v[186:187]
    v_pk_add_f32 v[100:101], v[100:101], v[188:189]
    v_pk_add_f32 v[102:103], v[102:103], v[190:191]
    v_pk_add_f32 v[96:97], v[96:97], s[86:87]
    buffer_load_dwordx4 v13, s[20:23], s52 offen offset:3072 lds
    v_pk_add_f32 v[98:99], v[98:99], s[86:87]
    v_pk_add_f32 v[100:101], v[100:101], s[86:87]
    v_pk_add_f32 v[102:103], v[102:103], s[86:87]
    v_cvt_pk_bf16_f32 v32, v96, v97
    v_cvt_pk_bf16_f32 v33, v98, v99
    v_cvt_pk_bf16_f32 v34, v100, v101
    s_mov_b32 s52, s96
    s_add_u32 s52, s52, 32768
    s_add_u32 m0, s97, 102400
    s_nop 0
    buffer_load_dwordx4 v10, s[20:23], s52 offen lds
    v_cvt_pk_bf16_f32 v35, v102, v103
    v_pk_mul_f32 v[184:185], v[104:105], s[84:85]
    v_pk_mul_f32 v[186:187], v[106:107], s[84:85]
    v_pk_mul_f32 v[188:189], v[108:109], s[84:85]
    v_pk_mul_f32 v[190:191], v[110:111], s[84:85]
    v_exp_f32 v184, v184 clamp
    buffer_load_dwordx4 v11, s[20:23], s52 offen offset:1024 lds
    v_exp_f32 v185, v185 clamp
    v_exp_f32 v186, v186 clamp
    v_exp_f32 v187, v187 clamp
    v_exp_f32 v188, v188 clamp
    v_exp_f32 v189, v189 clamp
    v_exp_f32 v190, v190 clamp
    buffer_load_dwordx4 v12, s[20:23], s52 offen offset:2048 lds
    v_exp_f32 v191, v191 clamp
    v_max_f32 v104, 0, v104
    v_max_f32 v105, 0, v105
    v_max_f32 v106, 0, v106
    v_max_f32 v107, 0, v107
    v_max_f32 v108, 0, v108
    buffer_load_dwordx4 v13, s[20:23], s52 offen offset:3072 lds
    v_max_f32 v109, 0, v109
    v_max_f32 v110, 0, v110
    v_max_f32 v111, 0, v111
    v_pk_add_f32 v[104:105], v[104:105], v[184:185]
    v_pk_add_f32 v[106:107], v[106:107], v[186:187]
    v_pk_add_f32 v[108:109], v[108:109], v[188:189]
    v_pk_add_f32 v[110:111], v[110:111], v[190:191]
    v_pk_add_f32 v[104:105], v[104:105], s[86:87]
    v_pk_add_f32 v[106:107], v[106:107], s[86:87]
    v_pk_add_f32 v[108:109], v[108:109], s[86:87]
    v_pk_add_f32 v[110:111], v[110:111], s[86:87]
    v_cvt_pk_bf16_f32 v36, v104, v105
    v_cvt_pk_bf16_f32 v37, v106, v107
    v_cvt_pk_bf16_f32 v38, v108, v109
    v_cvt_pk_bf16_f32 v39, v110, v111
    v_pk_mul_f32 v[184:185], v[112:113], s[84:85]
    v_pk_mul_f32 v[186:187], v[114:115], s[84:85]
    v_pk_mul_f32 v[188:189], v[116:117], s[84:85]
    v_pk_mul_f32 v[190:191], v[118:119], s[84:85]
    v_exp_f32 v184, v184 clamp
    v_exp_f32 v185, v185 clamp
    v_exp_f32 v186, v186 clamp
    v_exp_f32 v187, v187 clamp
    v_exp_f32 v188, v188 clamp
    v_exp_f32 v189, v189 clamp
    v_exp_f32 v190, v190 clamp
    v_exp_f32 v191, v191 clamp
    v_max_f32 v112, 0, v112
    v_max_f32 v113, 0, v113
    v_max_f32 v114, 0, v114
    v_max_f32 v115, 0, v115
    v_max_f32 v116, 0, v116
    v_max_f32 v117, 0, v117
    v_max_f32 v118, 0, v118
    v_max_f32 v119, 0, v119
    v_pk_add_f32 v[112:113], v[112:113], v[184:185]
    v_pk_add_f32 v[114:115], v[114:115], v[186:187]
    v_pk_add_f32 v[116:117], v[116:117], v[188:189]
    v_pk_add_f32 v[118:119], v[118:119], v[190:191]
    v_pk_add_f32 v[112:113], v[112:113], s[86:87]
    v_pk_add_f32 v[114:115], v[114:115], s[86:87]
    v_pk_add_f32 v[116:117], v[116:117], s[86:87]
    v_pk_add_f32 v[118:119], v[118:119], s[86:87]
    v_cvt_pk_bf16_f32 v40, v112, v113
    v_cvt_pk_bf16_f32 v41, v114, v115
    v_cvt_pk_bf16_f32 v42, v116, v117
    v_cvt_pk_bf16_f32 v43, v118, v119
    v_pk_mul_f32 v[184:185], v[120:121], s[84:85]
    v_pk_mul_f32 v[186:187], v[122:123], s[84:85]
    v_pk_mul_f32 v[188:189], v[124:125], s[84:85]
    v_pk_mul_f32 v[190:191], v[126:127], s[84:85]
    v_exp_f32 v184, v184 clamp
    v_exp_f32 v185, v185 clamp
    v_exp_f32 v186, v186 clamp
    v_exp_f32 v187, v187 clamp
    v_exp_f32 v188, v188 clamp
    v_exp_f32 v189, v189 clamp
    v_exp_f32 v190, v190 clamp
    v_exp_f32 v191, v191 clamp
    v_max_f32 v120, 0, v120
    v_max_f32 v121, 0, v121
    v_max_f32 v122, 0, v122
    v_max_f32 v123, 0, v123
    v_max_f32 v124, 0, v124
    v_max_f32 v125, 0, v125
    v_max_f32 v126, 0, v126
    v_max_f32 v127, 0, v127
    v_pk_add_f32 v[120:121], v[120:121], v[184:185]
    v_pk_add_f32 v[122:123], v[122:123], v[186:187]
    v_pk_add_f32 v[124:125], v[124:125], v[188:189]
    v_pk_add_f32 v[126:127], v[126:127], v[190:191]
    v_pk_add_f32 v[120:121], v[120:121], s[86:87]
    v_pk_add_f32 v[122:123], v[122:123], s[86:87]
    v_pk_add_f32 v[124:125], v[124:125], s[86:87]
    v_pk_add_f32 v[126:127], v[126:127], s[86:87]
    v_cvt_pk_bf16_f32 v44, v120, v121
    v_cvt_pk_bf16_f32 v45, v122, v123
    v_cvt_pk_bf16_f32 v46, v124, v125
    v_cvt_pk_bf16_f32 v47, v126, v127
    s_lshl_b32 s100, s59, 11
    s_add_u32 s100, s100, 1048576
    s_xor_b32 s101, s100, 2048
    s_mov_b32 s98, 0xff00ff00
    s_mov_b32 s99, 0xff00ff00
    v_lshrrev_b32 v31, 4, v1
    v_lshlrev_b32 v31, 7, v31
    v_and_b32 v30, 7, v1
    v_lshl_add_u32 v31, v30, 4, v31
    buffer_load_dwordx4 v[64:67], v31, s[24:27], s100 offen offset:0 sc1
    buffer_load_dwordx4 v[68:71], v31, s[24:27], s100 offen offset:512 sc1
    buffer_load_dwordx4 v[80:83], v31, s[24:27], s101 offen offset:0 sc1
    buffer_load_dwordx4 v[84:87], v31, s[24:27], s101 offen offset:512 sc1
    s_mov_b32 s88, 32768
    s_waitcnt vmcnt(0)
    v_min_u32 v28, v67, v71
    v_max_u32 v29, v67, v71
    v_min3_u32 v28, v28, v83, v87
    v_max3_u32 v29, v29, v83, v87
    v_xor_b32 v28, v26, v28
    v_xor_b32 v29, v26, v29
    v_or_b32 v28, v28, v29
    v_cmp_ne_u32 vcc, 0, v28
    s_nop 4
    s_cbranch_vccz L_h2A_ok
L_h2A:
    buffer_load_dwordx4 v[64:67], v31, s[24:27], s100 offen offset:0 sc1
    buffer_load_dwordx4 v[68:71], v31, s[24:27], s100 offen offset:512 sc1
    buffer_load_dwordx4 v[80:83], v31, s[24:27], s101 offen offset:0 sc1
    buffer_load_dwordx4 v[84:87], v31, s[24:27], s101 offen offset:512 sc1
    s_waitcnt vmcnt(0)
    v_min_u32 v28, v67, v71
    v_max_u32 v29, v67, v71
    v_min3_u32 v28, v28, v83, v87
    v_max3_u32 v29, v29, v83, v87
    v_xor_b32 v28, v26, v28
    v_xor_b32 v29, v26, v29
    v_or_b32 v28, v28, v29
    v_cmp_ne_u32 vcc, 0, v28
    s_nop 4
    s_cbranch_vccz L_h2A_ok
    s_sub_u32 s88, s88, 1
    s_cmp_gt_i32 s88, 0
    s_cbranch_scc1 L_h2A
L_h2A_ok:
    v_cndmask_b32_e64 v216, v64, v65, s[98:99]
    v_cndmask_b32_e64 v217, v68, v69, s[98:99]
    v_mov_b32 v218, v66
    v_mov_b32 v219, v70
    v_cndmask_b32_e64 v224, v80, v81, s[98:99]
    v_cndmask_b32_e64 v225, v84, v85, s[98:99]
    v_mov_b32 v226, v82
    v_mov_b32 v227, v86
    v_permlane16_swap_b32 v216, v218
    v_permlane16_swap_b32 v217, v219
    v_permlane16_swap_b32 v224, v226
    v_permlane16_swap_b32 v225, v227
    v_mfma_f32_32x32x16_bf16 v[64:79], v[216:219], v[32:35], 0
    s_lshl_b32 s53, s43, 2
    s_lshl_b32 s54, s41, 1
    s_add_u32 s53, s53, s54
    s_lshl_b32 s53, s53, 16
    s_lshl_b32 s54, s59, 10
    s_add_u32 s53, s53, s54
    s_add_u32 s53, s53, 2097152
    s_xor_b32 s54, s53, 1024
    s_add_u32 s55, s53, 65536
    s_add_u32 s56, s54, 65536
    v_lshlrev_b32 v27, 4, v1
    v_mfma_f32_32x32x16_bf16 v[80:95], v[224:227], v[36:39], 0
    v_mfma_f32_32x32x16_bf16 v[96:111], v[216:219], v[40:43], 0
    v_mfma_f32_32x32x16_bf16 v[112:127], v[224:227], v[44:47], 0
    v_add_f32 v72, s86, v72
    v_rcp_f32 v72, v72
    s_nop 0
    v_pk_mul_f32 v[64:65], v[64:65], v[72:73] op_sel_hi:[1,0]
    v_pk_mul_f32 v[66:67], v[66:67], v[72:73] op_sel_hi:[1,0]
    v_pk_mul_f32 v[68:69], v[68:69], v[72:73] op_sel_hi:[1,0]
    v_pk_mul_f32 v[70:71], v[70:71], v[72:73] op_sel_hi:[1,0]
    v_cvt_pk_bf16_f32 v232, v64, v65
    v_cvt_pk_bf16_f32 v233, v66, v67
    v_cvt_pk_bf16_f32 v234, v68, v69
    v_cvt_pk_bf16_f32 v235, v70, v71
    buffer_store_dwordx4 v[232:235], v27, s[24:27], s53 offen sc1
    v_add_f32 v88, s86, v88
    v_rcp_f32 v88, v88
    s_nop 0
    v_pk_mul_f32 v[80:81], v[80:81], v[88:89] op_sel_hi:[1,0]
    v_pk_mul_f32 v[82:83], v[82:83], v[88:89] op_sel_hi:[1,0]
    v_pk_mul_f32 v[84:85], v[84:85], v[88:89] op_sel_hi:[1,0]
    v_pk_mul_f32 v[86:87], v[86:87], v[88:89] op_sel_hi:[1,0]
    v_cvt_pk_bf16_f32 v236, v80, v81
    v_cvt_pk_bf16_f32 v237, v82, v83
    v_cvt_pk_bf16_f32 v238, v84, v85
    v_cvt_pk_bf16_f32 v239, v86, v87
    buffer_store_dwordx4 v[236:239], v27, s[24:27], s54 offen sc1
    v_add_f32 v104, s86, v104
    v_rcp_f32 v104, v104
    s_nop 0
    v_pk_mul_f32 v[96:97], v[96:97], v[104:105] op_sel_hi:[1,0]
    v_pk_mul_f32 v[98:99], v[98:99], v[104:105] op_sel_hi:[1,0]
    v_pk_mul_f32 v[100:101], v[100:101], v[104:105] op_sel_hi:[1,0]
    v_pk_mul_f32 v[102:103], v[102:103], v[104:105] op_sel_hi:[1,0]
    v_cvt_pk_bf16_f32 v240, v96, v97
    v_cvt_pk_bf16_f32 v241, v98, v99
    v_cvt_pk_bf16_f32 v242, v100, v101
    v_cvt_pk_bf16_f32 v243, v102, v103
    buffer_store_dwordx4 v[240:243], v27, s[24:27], s55 offen sc1
    v_add_f32 v120, s86, v120
    v_rcp_f32 v120, v120
    s_nop 0
    v_pk_mul_f32 v[112:113], v[112:113], v[120:121] op_sel_hi:[1,0]
    v_pk_mul_f32 v[114:115], v[114:115], v[120:121] op_sel_hi:[1,0]
    v_pk_mul_f32 v[116:117], v[116:117], v[120:121] op_sel_hi:[1,0]
    v_pk_mul_f32 v[118:119], v[118:119], v[120:121] op_sel_hi:[1,0]
    v_cvt_pk_bf16_f32 v244, v112, v113
    v_cvt_pk_bf16_f32 v245, v114, v115
    v_cvt_pk_bf16_f32 v246, v116, v117
    v_cvt_pk_bf16_f32 v247, v118, v119
    buffer_store_dwordx4 v[244:247], v27, s[24:27], s56 offen sc1
    s_lshl_b32 s53, s43, 1
    s_add_u32 s53, s53, s41
    s_lshl_b32 s53, s53, 5
    s_lshl_b32 s54, s44, 1
    s_add_u32 s53, s53, s54
    s_add_u32 s53, s53, s42
    s_add_u32 s53, s53, 0
    s_lshl_b32 s53, s53, 7
    s_add_u32 s100, s53, 131072
    s_barrier
    v_lshrrev_b32 v27, 5, v1
    v_lshlrev_b32 v27, 2, v27
    v_bfe_u32 v28, v1, 2, 2
    v_add_u32 v27, v27, v28
    v_lshlrev_b32 v27, 7, v27
    v_bfe_u32 v29, v1, 4, 1
    v_lshl_add_u32 v27, v29, 5, v27
    v_and_b32 v29, 3, v1
    v_lshl_add_u32 v27, v29, 3, v27
    s_and_b32 s53, s6, 1
    s_xor_b32 s53, s53, s42
    s_lshl_b32 s53, s53, 16
    s_add_u32 s53, s53, 32768
    v_add_u32 v27, s53, v27
    v_lshrrev_b32 v28, 1, v28
    v_lshl_add_u32 v2, v28, 6, v27
    v_xor_b32 v28, 1, v28
    v_lshl_add_u32 v3, v28, 6, v27
    v_and_b32 v27, 31, v1
    s_lshl_b32 s53, s42, 14
    s_lshl_b32 s54, s41, 13
    s_add_u32 s53, s53, s54
    v_lshlrev_b32 v28, 8, v27
    v_add_u32 v28, s53, v28
    v_and_b32 v29, 7, v27
    v_lshrrev_b32 v27, 5, v1
    v_xor_b32 v29, v29, v27
    v_xor_b32 v27, 0, v29
    v_lshl_add_u32 v4, v27, 4, v28
    v_xor_b32 v27, 2, v29
    v_lshl_add_u32 v5, v27, 4, v28
    v_xor_b32 v27, 4, v29
    v_lshl_add_u32 v6, v27, 4, v28
    v_xor_b32 v27, 6, v29
    v_lshl_add_u32 v7, v27, 4, v28
    v_lshrrev_b32 v27, 3, v1
    v_and_b32 v28, 7, v1
    v_lshlrev_b32 v28, 1, v28
    s_lshl_b32 s53, s40, 12
    v_lshlrev_b32 v29, 8, v27
    v_add_u32 v29, s53, v29
    v_or_b32 v30, 0, v28
    v_xor_b32 v30, v30, v27
    v_lshl_add_u32 v8, v30, 4, v29
    v_or_b32 v30, 1, v28
    v_xor_b32 v30, v30, v27
    v_lshl_add_u32 v9, v30, 4, v29
    v_and_b32 v28, 7, v1
    v_lshlrev_b32 v28, 4, v28
    v_lshl_add_u32 v14, v27, 10, v28
    v_and_b32 v15, 15, v1
    v_lshlrev_b32 v15, 7, v15
    v_lshlrev_b32 v16, 4, v1
    v_and_b32 v28, 31, v1
    v_lshrrev_b32 v29, 2, v28
    v_lshlrev_b32 v29, 7, v29
    v_and_b32 v28, 3, v28
    v_lshl_add_u32 v17, v28, 3, v29
    s_lshl_b32 s53, s57, 1
    s_add_u32 s53, s53, s42
    s_lshl_b32 s53, s53, 11
    s_add_u32 s47, s53, 131072
    s_lshl_b32 s53, s57, 1
    s_add_u32 s53, s53, s41
    s_lshl_b32 s54, s53, 16
    s_lshl_b32 s55, s42, 15
    s_add_u32 s54, s54, s55
    s_add_u32 s48, s54, 2097152
    s_lshl_b32 s53, s53, 10
    s_add_u32 s49, s53, 4096
    s_lshl_b32 s53, s57, 6
    s_lshl_b32 s54, s40, 4
    s_add_u32 s53, s53, s54
    s_lshl_b32 s53, s53, 10
    s_lshl_b32 s54, s58, 7
    s_add_u32 s50, s53, s54
    s_add_u32 s51, s50, 8192
    s_mov_b32 s7, s58
    s_lshr_b32 s3, s6, 1
    s_lshl_b32 s3, s3, 2
    v_mov_b32 v27, 0
    s_waitcnt vmcnt(0)
    s_mov_b64 exec, 1
    buffer_store_dword v26, v27, s[24:27], s100 offen sc1
    s_mov_b64 exec, -1
    s_xor_b32 s52, s96, 262144
    s_add_u32 m0, s97, 131072
    s_nop 0
    buffer_load_dwordx4 v10, s[20:23], s52 offen lds
    buffer_load_dwordx4 v11, s[20:23], s52 offen offset:1024 lds
    buffer_load_dwordx4 v12, s[20:23], s52 offen offset:2048 lds
    buffer_load_dwordx4 v13, s[20:23], s52 offen offset:3072 lds
    s_xor_b32 s52, s96, 262144
    s_add_u32 s52, s52, 32768
    s_add_u32 m0, s97, 135168
    s_nop 0
    buffer_load_dwordx4 v10, s[20:23], s52 offen lds
    buffer_load_dwordx4 v11, s[20:23], s52 offen offset:1024 lds
    buffer_load_dwordx4 v12, s[20:23], s52 offen offset:2048 lds
    buffer_load_dwordx4 v13, s[20:23], s52 offen offset:3072 lds
    s_waitcnt vmcnt(0)
    s_barrier
    buffer_load_dwordx2 v[96:97], v17, s[24:27], s49 offen sc1
    s_mov_b32 s88, 32768
L_flA:
    buffer_load_dword v28, v15, s[24:27], s47 offen sc1
    s_waitcnt vmcnt(0)
    v_cmp_ne_u32 vcc, v28, v26
    s_nop 4
    s_cbranch_vccz L_flA_ok
    s_sub_u32 s88, s88, 1
    s_cmp_gt_i32 s88, 0
    s_cbranch_scc1 L_flA
L_flA_ok:
    s_add_u32 s55, s7, 0
    s_and_b32 s55, s55, 7
    s_add_u32 s55, s55, s3
    s_and_b32 s55, s55, 7
    s_lshl_b32 s55, s55, 12
    s_add_u32 s54, s48, s55
    buffer_load_dwordx4 a[0:3], v16, s[24:27], s54 offen offset:0 sc1
    buffer_load_dwordx4 a[4:7], v16, s[24:27], s54 offen offset:1024 sc1
    buffer_load_dwordx4 a[8:11], v16, s[24:27], s54 offen offset:2048 sc1
    buffer_load_dwordx4 a[12:15], v16, s[24:27], s54 offen offset:3072 sc1
    s_add_u32 s55, s7, 1
    s_and_b32 s55, s55, 7
    s_add_u32 s55, s55, s3
    s_and_b32 s55, s55, 7
    s_lshl_b32 s55, s55, 12
    s_add_u32 s54, s48, s55
    buffer_load_dwordx4 a[16:19], v16, s[24:27], s54 offen offset:0 sc1
    buffer_load_dwordx4 a[20:23], v16, s[24:27], s54 offen offset:1024 sc1
    buffer_load_dwordx4 a[24:27], v16, s[24:27], s54 offen offset:2048 sc1
    buffer_load_dwordx4 a[28:31], v16, s[24:27], s54 offen offset:3072 sc1
    s_add_u32 s55, s7, 2
    s_and_b32 s55, s55, 7
    s_add_u32 s55, s55, s3
    s_and_b32 s55, s55, 7
    s_lshl_b32 s55, s55, 12
    s_add_u32 s54, s48, s55
    buffer_load_dwordx4 a[32:35], v16, s[24:27], s54 offen offset:0 sc1
    buffer_load_dwordx4 a[36:39], v16, s[24:27], s54 offen offset:1024 sc1
    buffer_load_dwordx4 a[40:43], v16, s[24:27], s54 offen offset:2048 sc1
    buffer_load_dwordx4 a[44:47], v16, s[24:27], s54 offen offset:3072 sc1
    s_add_u32 s53, s7, 0
    s_and_b32 s53, s53, 7
    s_lshl_b32 s53, s53, 13
    v_add_u32 v18, s53, v2
    v_add_u32 v19, s53, v3
    ds_read_b64_tr_b16 v[128:129], v18 offset:0
    ds_read_b64_tr_b16 v[130:131], v18 offset:1024
    ds_read_b64_tr_b16 v[132:133], v19 offset:0
    ds_read_b64_tr_b16 v[134:135], v19 offset:1024
    ds_read_b64_tr_b16 v[136:137], v18 offset:2048
    ds_read_b64_tr_b16 v[138:139], v18 offset:3072
    ds_read_b64_tr_b16 v[140:141], v19 offset:2048
    ds_read_b64_tr_b16 v[142:143], v19 offset:3072
    s_mov_b32 s88, 32768
    v_cmp_ne_u32 vcc, v97, v26
    s_nop 4
    s_cbranch_vccz L_gA_ok
L_gA:
    buffer_load_dwordx2 v[96:97], v17, s[24:27], s49 offen sc1
    s_waitcnt vmcnt(0)
    v_cmp_ne_u32 vcc, v97, v26
    s_nop 4
    s_cbranch_vccz L_gA_ok
    s_sub_u32 s88, s88, 1
    s_cmp_gt_i32 s88, 0
    s_cbranch_scc1 L_gA
L_gA_ok:
    v_sub_f32 v97, 1.0, v96
    s_cmp_eq_u32 s42, 0
    s_cselect_b64 vcc, 0, -1
    v_cndmask_b32 v96, v96, v97, vcc
    s_waitcnt vmcnt(11) lgkmcnt(4)
    v_mfma_f32_32x32x16_bf16 v[64:79], v[128:131], a[0:3], 0
    ds_read_b64_tr_b16 v[144:145], v18 offset:4096
    ds_read_b64_tr_b16 v[146:147], v18 offset:5120
    s_add_u32 s55, s7, 3
    s_and_b32 s55, s55, 7
    s_add_u32 s55, s55, s3
    s_and_b32 s55, s55, 7
    s_lshl_b32 s55, s55, 12
    s_add_u32 s54, s48, s55
    buffer_load_dwordx4 a[48:51], v16, s[24:27], s54 offen offset:0 sc1
    v_mfma_f32_32x32x16_bf16 v[80:95], v[132:135], a[0:3], 0
    ds_read_b64_tr_b16 v[148:149], v19 offset:4096
    ds_read_b64_tr_b16 v[150:151], v19 offset:5120
    s_waitcnt vmcnt(11) lgkmcnt(4)
    v_mfma_f32_32x32x16_bf16 v[64:79], v[136:139], a[4:7], v[64:79]
    ds_read_b64_tr_b16 v[128:129], v18 offset:6144
    ds_read_b64_tr_b16 v[130:131], v18 offset:7168
    buffer_load_dwordx4 a[52:55], v16, s[24:27], s54 offen offset:1024 sc1
    v_mfma_f32_32x32x16_bf16 v[80:95], v[140:143], a[4:7], v[80:95]
    ds_read_b64_tr_b16 v[132:133], v19 offset:6144
    ds_read_b64_tr_b16 v[134:135], v19 offset:7168
    s_waitcnt vmcnt(11) lgkmcnt(4)
    v_mfma_f32_32x32x16_bf16 v[64:79], v[144:147], a[8:11], v[64:79]
    s_add_u32 s53, s7, 1
    s_and_b32 s53, s53, 7
    s_lshl_b32 s53, s53, 13
    v_add_u32 v20, s53, v2
    v_add_u32 v21, s53, v3
    ds_read_b64_tr_b16 v[136:137], v20 offset:0
    ds_read_b64_tr_b16 v[138:139], v20 offset:1024
    buffer_load_dwordx4 a[56:59], v16, s[24:27], s54 offen offset:2048 sc1
    v_mfma_f32_32x32x16_bf16 v[80:95], v[148:151], a[8:11], v[80:95]
    ds_read_b64_tr_b16 v[140:141], v21 offset:0
    ds_read_b64_tr_b16 v[142:143], v21 offset:1024
    s_waitcnt vmcnt(11) lgkmcnt(4)
    v_mfma_f32_32x32x16_bf16 v[64:79], v[128:131], a[12:15], v[64:79]
    ds_read_b64_tr_b16 v[144:145], v20 offset:2048
    ds_read_b64_tr_b16 v[146:147], v20 offset:3072
    buffer_load_dwordx4 a[60:63], v16, s[24:27], s54 offen offset:3072 sc1
    v_mfma_f32_32x32x16_bf16 v[80:95], v[132:135], a[12:15], v[80:95]
    ds_read_b64_tr_b16 v[148:149], v21 offset:2048
    ds_read_b64_tr_b16 v[150:151], v21 offset:3072
    s_waitcnt vmcnt(11) lgkmcnt(4)
    v_mfma_f32_32x32x16_bf16 v[64:79], v[136:139], a[16:19], v[64:79]
    ds_read_b64_tr_b16 v[128:129], v20 offset:4096
    ds_read_b64_tr_b16 v[130:131], v20 offset:5120
    s_add_u32 s55, s7, 4
    s_and_b32 s55, s55, 7
    s_add_u32 s55, s55, s3
    s_and_b32 s55, s55, 7
    s_lshl_b32 s55, s55, 12
    s_add_u32 s54, s48, s55
    buffer_load_dwordx4 a[64:67], v16, s[24:27], s54 offen offset:0 sc1
    v_mfma_f32_32x32x16_bf16 v[80:95], v[140:143], a[16:19], v[80:95]
    ds_read_b64_tr_b16 v[132:133], v21 offset:4096
    ds_read_b64_tr_b16 v[134:135], v21 offset:5120
    s_waitcnt vmcnt(11) lgkmcnt(4)
    v_mfma_f32_32x32x16_bf16 v[64:79], v[144:147], a[20:23], v[64:79]
    ds_read_b64_tr_b16 v[136:137], v20 offset:6144
    ds_read_b64_tr_b16 v[138:139], v20 offset:7168
    buffer_load_dwordx4 a[68:71], v16, s[24:27], s54 offen offset:1024 sc1
    v_mfma_f32_32x32x16_bf16 v[80:95], v[148:151], a[20:23], v[80:95]
    ds_read_b64_tr_b16 v[140:141], v21 offset:6144
    ds_read_b64_tr_b16 v[142:143], v21 offset:7168
    s_waitcnt vmcnt(11) lgkmcnt(4)
    v_mfma_f32_32x32x16_bf16 v[64:79], v[128:131], a[24:27], v[64:79]
    s_add_u32 s53, s7, 2
    s_and_b32 s53, s53, 7
    s_lshl_b32 s53, s53, 13
    v_add_u32 v18, s53, v2
    v_add_u32 v19, s53, v3
    ds_read_b64_tr_b16 v[144:145], v18 offset:0
    ds_read_b64_tr_b16 v[146:147], v18 offset:1024
    buffer_load_dwordx4 a[72:75], v16, s[24:27], s54 offen offset:2048 sc1
    v_mfma_f32_32x32x16_bf16 v[80:95], v[132:135], a[24:27], v[80:95]
    ds_read_b64_tr_b16 v[148:149], v19 offset:0
    ds_read_b64_tr_b16 v[150:151], v19 offset:1024
    s_waitcnt vmcnt(11) lgkmcnt(4)
    v_mfma_f32_32x32x16_bf16 v[64:79], v[136:139], a[28:31], v[64:79]
    ds_read_b64_tr_b16 v[128:129], v18 offset:2048
    ds_read_b64_tr_b16 v[130:131], v18 offset:3072
    buffer_load_dwordx4 a[76:79], v16, s[24:27], s54 offen offset:3072 sc1
    v_mfma_f32_32x32x16_bf16 v[80:95], v[140:143], a[28:31], v[80:95]
    ds_read_b64_tr_b16 v[132:133], v19 offset:2048
    ds_read_b64_tr_b16 v[134:135], v19 offset:3072
    s_waitcnt vmcnt(11) lgkmcnt(4)
    v_mfma_f32_32x32x16_bf16 v[64:79], v[144:147], a[32:35], v[64:79]
    ds_read_b64_tr_b16 v[136:137], v18 offset:4096
    ds_read_b64_tr_b16 v[138:139], v18 offset:5120
    s_add_u32 s55, s7, 5
    s_and_b32 s55, s55, 7
    s_add_u32 s55, s55, s3
    s_and_b32 s55, s55, 7
    s_lshl_b32 s55, s55, 12
    s_add_u32 s54, s48, s55
    buffer_load_dwordx4 a[80:83], v16, s[24:27], s54 offen offset:0 sc1
    v_mfma_f32_32x32x16_bf16 v[80:95], v[148:151], a[32:35], v[80:95]
    ds_read_b64_tr_b16 v[140:141], v19 offset:4096
    ds_read_b64_tr_b16 v[142:143], v19 offset:5120
    s_waitcnt vmcnt(11) lgkmcnt(4)
    v_mfma_f32_32x32x16_bf16 v[64:79], v[128:131], a[36:39], v[64:79]
    ds_read_b64_tr_b16 v[144:145], v18 offset:6144
    ds_read_b64_tr_b16 v[146:147], v18 offset:7168
    buffer_load_dwordx4 a[84:87], v16, s[24:27], s54 offen offset:1024 sc1
    v_mfma_f32_32x32x16_bf16 v[80:95], v[132:135], a[36:39], v[80:95]
    ds_read_b64_tr_b16 v[148:149], v19 offset:6144
    ds_read_b64_tr_b16 v[150:151], v19 offset:7168
    s_waitcnt vmcnt(11) lgkmcnt(4)
    v_mfma_f32_32x32x16_bf16 v[64:79], v[136:139], a[40:43], v[64:79]
    s_add_u32 s53, s7, 3
    s_and_b32 s53, s53, 7
    s_lshl_b32 s53, s53, 13
    v_add_u32 v20, s53, v2
    v_add_u32 v21, s53, v3
    ds_read_b64_tr_b16 v[128:129], v20 offset:0
    ds_read_b64_tr_b16 v[130:131], v20 offset:1024
    buffer_load_dwordx4 a[88:91], v16, s[24:27], s54 offen offset:2048 sc1
    v_mfma_f32_32x32x16_bf16 v[80:95], v[140:143], a[40:43], v[80:95]
    ds_read_b64_tr_b16 v[132:133], v21 offset:0
    ds_read_b64_tr_b16 v[134:135], v21 offset:1024
    s_waitcnt vmcnt(11) lgkmcnt(4)
    v_mfma_f32_32x32x16_bf16 v[64:79], v[144:147], a[44:47], v[64:79]
    ds_read_b64_tr_b16 v[136:137], v20 offset:2048
    ds_read_b64_tr_b16 v[138:139], v20 offset:3072
    buffer_load_dwordx4 a[92:95], v16, s[24:27], s54 offen offset:3072 sc1
    v_mfma_f32_32x32x16_bf16 v[80:95], v[148:151], a[44:47], v[80:95]
    ds_read_b64_tr_b16 v[140:141], v21 offset:2048
    ds_read_b64_tr_b16 v[142:143], v21 offset:3072
    s_waitcnt vmcnt(11) lgkmcnt(4)
    v_mfma_f32_32x32x16_bf16 v[64:79], v[128:131], a[48:51], v[64:79]
    ds_read_b64_tr_b16 v[144:145], v20 offset:4096
    ds_read_b64_tr_b16 v[146:147], v20 offset:5120
    s_add_u32 s55, s7, 6
    s_and_b32 s55, s55, 7
    s_add_u32 s55, s55, s3
    s_and_b32 s55, s55, 7
    s_lshl_b32 s55, s55, 12
    s_add_u32 s54, s48, s55
    buffer_load_dwordx4 a[96:99], v16, s[24:27], s54 offen offset:0 sc1
    v_mfma_f32_32x32x16_bf16 v[80:95], v[132:135], a[48:51], v[80:95]
    ds_read_b64_tr_b16 v[148:149], v21 offset:4096
    ds_read_b64_tr_b16 v[150:151], v21 offset:5120
    s_waitcnt vmcnt(11) lgkmcnt(4)
    v_mfma_f32_32x32x16_bf16 v[64:79], v[136:139], a[52:55], v[64:79]
    ds_read_b64_tr_b16 v[128:129], v20 offset:6144
    ds_read_b64_tr_b16 v[130:131], v20 offset:7168
    buffer_load_dwordx4 a[100:103], v16, s[24:27], s54 offen offset:1024 sc1
    v_mfma_f32_32x32x16_bf16 v[80:95], v[140:143], a[52:55], v[80:95]
    ds_read_b64_tr_b16 v[132:133], v21 offset:6144
    ds_read_b64_tr_b16 v[134:135], v21 offset:7168
    s_waitcnt vmcnt(11) lgkmcnt(4)
    v_mfma_f32_32x32x16_bf16 v[64:79], v[144:147], a[56:59], v[64:79]
    s_add_u32 s53, s7, 4
    s_and_b32 s53, s53, 7
    s_lshl_b32 s53, s53, 13
    v_add_u32 v18, s53, v2
    v_add_u32 v19, s53, v3
    ds_read_b64_tr_b16 v[136:137], v18 offset:0
    ds_read_b64_tr_b16 v[138:139], v18 offset:1024
    buffer_load_dwordx4 a[104:107], v16, s[24:27], s54 offen offset:2048 sc1
    v_mfma_f32_32x32x16_bf16 v[80:95], v[148:151], a[56:59], v[80:95]
    ds_read_b64_tr_b16 v[140:141], v19 offset:0
    ds_read_b64_tr_b16 v[142:143], v19 offset:1024
    s_waitcnt vmcnt(11) lgkmcnt(4)
    v_mfma_f32_32x32x16_bf16 v[64:79], v[128:131], a[60:63], v[64:79]
    ds_read_b64_tr_b16 v[144:145], v18 offset:2048
    ds_read_b64_tr_b16 v[146:147], v18 offset:3072
    buffer_load_dwordx4 a[108:111], v16, s[24:27], s54 offen offset:3072 sc1
    v_mfma_f32_32x32x16_bf16 v[80:95], v[132:135], a[60:63], v[80:95]
    ds_read_b64_tr_b16 v[148:149], v19 offset:2048
    ds_read_b64_tr_b16 v[150:151], v19 offset:3072
    s_waitcnt vmcnt(11) lgkmcnt(4)
    v_mfma_f32_32x32x16_bf16 v[64:79], v[136:139], a[64:67], v[64:79]
    ds_read_b64_tr_b16 v[128:129], v18 offset:4096
    ds_read_b64_tr_b16 v[130:131], v18 offset:5120
    s_add_u32 s55, s7, 7
    s_and_b32 s55, s55, 7
    s_add_u32 s55, s55, s3
    s_and_b32 s55, s55, 7
    s_lshl_b32 s55, s55, 12
    s_add_u32 s54, s48, s55
    buffer_load_dwordx4 a[112:115], v16, s[24:27], s54 offen offset:0 sc1
    v_mfma_f32_32x32x16_bf16 v[80:95], v[140:143], a[64:67], v[80:95]
    ds_read_b64_tr_b16 v[132:133], v19 offset:4096
    ds_read_b64_tr_b16 v[134:135], v19 offset:5120
    s_waitcnt vmcnt(11) lgkmcnt(4)
    v_mfma_f32_32x32x16_bf16 v[64:79], v[144:147], a[68:71], v[64:79]
    ds_read_b64_tr_b16 v[136:137], v18 offset:6144
    ds_read_b64_tr_b16 v[138:139], v18 offset:7168
    buffer_load_dwordx4 a[116:119], v16, s[24:27], s54 offen offset:1024 sc1
    v_mfma_f32_32x32x16_bf16 v[80:95], v[148:151], a[68:71], v[80:95]
    ds_read_b64_tr_b16 v[140:141], v19 offset:6144
    ds_read_b64_tr_b16 v[142:143], v19 offset:7168
    s_waitcnt vmcnt(11) lgkmcnt(4)
    v_mfma_f32_32x32x16_bf16 v[64:79], v[128:131], a[72:75], v[64:79]
    s_add_u32 s53, s7, 5
    s_and_b32 s53, s53, 7
    s_lshl_b32 s53, s53, 13
    v_add_u32 v20, s53, v2
    v_add_u32 v21, s53, v3
    ds_read_b64_tr_b16 v[144:145], v20 offset:0
    ds_read_b64_tr_b16 v[146:147], v20 offset:1024
    buffer_load_dwordx4 a[120:123], v16, s[24:27], s54 offen offset:2048 sc1
    v_mfma_f32_32x32x16_bf16 v[80:95], v[132:135], a[72:75], v[80:95]
    ds_read_b64_tr_b16 v[148:149], v21 offset:0
    ds_read_b64_tr_b16 v[150:151], v21 offset:1024
    s_waitcnt vmcnt(11) lgkmcnt(4)
    v_mfma_f32_32x32x16_bf16 v[64:79], v[136:139], a[76:79], v[64:79]
    ds_read_b64_tr_b16 v[128:129], v20 offset:2048
    ds_read_b64_tr_b16 v[130:131], v20 offset:3072
    buffer_load_dwordx4 a[124:127], v16, s[24:27], s54 offen offset:3072 sc1
    v_mfma_f32_32x32x16_bf16 v[80:95], v[140:143], a[76:79], v[80:95]
    ds_read_b64_tr_b16 v[132:133], v21 offset:2048
    ds_read_b64_tr_b16 v[134:135], v21 offset:3072
    s_waitcnt vmcnt(11) lgkmcnt(4)
    v_mfma_f32_32x32x16_bf16 v[64:79], v[144:147], a[80:83], v[64:79]
    ds_read_b64_tr_b16 v[136:137], v20 offset:4096
    ds_read_b64_tr_b16 v[138:139], v20 offset:5120
    v_mfma_f32_32x32x16_bf16 v[80:95], v[148:151], a[80:83], v[80:95]
    ds_read_b64_tr_b16 v[140:141], v21 offset:4096
    ds_read_b64_tr_b16 v[142:143], v21 offset:5120
    s_waitcnt vmcnt(10) lgkmcnt(4)
    v_mfma_f32_32x32x16_bf16 v[64:79], v[128:131], a[84:87], v[64:79]
    ds_read_b64_tr_b16 v[144:145], v20 offset:6144
    ds_read_b64_tr_b16 v[146:147], v20 offset:7168
    v_mfma_f32_32x32x16_bf16 v[80:95], v[132:135], a[84:87], v[80:95]
    ds_read_b64_tr_b16 v[148:149], v21 offset:6144
    ds_read_b64_tr_b16 v[150:151], v21 offset:7168
    s_waitcnt vmcnt(9) lgkmcnt(4)
    v_mfma_f32_32x32x16_bf16 v[64:79], v[136:139], a[88:91], v[64:79]
    s_add_u32 s53, s7, 6
    s_and_b32 s53, s53, 7
    s_lshl_b32 s53, s53, 13
    v_add_u32 v18, s53, v2
    v_add_u32 v19, s53, v3
    ds_read_b64_tr_b16 v[128:129], v18 offset:0
    ds_read_b64_tr_b16 v[130:131], v18 offset:1024
    v_mfma_f32_32x32x16_bf16 v[80:95], v[140:143], a[88:91], v[80:95]
    ds_read_b64_tr_b16 v[132:133], v19 offset:0
    ds_read_b64_tr_b16 v[134:135], v19 offset:1024
    s_waitcnt vmcnt(8) lgkmcnt(4)
    v_mfma_f32_32x32x16_bf16 v[64:79], v[144:147], a[92:95], v[64:79]
    ds_read_b64_tr_b16 v[136:137], v18 offset:2048
    ds_read_b64_tr_b16 v[138:139], v18 offset:3072
    v_mfma_f32_32x32x16_bf16 v[80:95], v[148:151], a[92:95], v[80:95]
    ds_read_b64_tr_b16 v[140:141], v19 offset:2048
    ds_read_b64_tr_b16 v[142:143], v19 offset:3072
    s_waitcnt vmcnt(7) lgkmcnt(4)
    v_mfma_f32_32x32x16_bf16 v[64:79], v[128:131], a[96:99], v[64:79]
    ds_read_b64_tr_b16 v[144:145], v18 offset:4096
    ds_read_b64_tr_b16 v[146:147], v18 offset:5120
    v_mfma_f32_32x32x16_bf16 v[80:95], v[132:135], a[96:99], v[80:95]
    ds_read_b64_tr_b16 v[148:149], v19 offset:4096
    ds_read_b64_tr_b16 v[150:151], v19 offset:5120
    s_waitcnt vmcnt(6) lgkmcnt(4)
    v_mfma_f32_32x32x16_bf16 v[64:79], v[136:139], a[100:103], v[64:79]
    ds_read_b64_tr_b16 v[128:129], v18 offset:6144
    ds_read_b64_tr_b16 v[130:131], v18 offset:7168
    v_mfma_f32_32x32x16_bf16 v[80:95], v[140:143], a[100:103], v[80:95]
    ds_read_b64_tr_b16 v[132:133], v19 offset:6144
    ds_read_b64_tr_b16 v[134:135], v19 offset:7168
    s_waitcnt vmcnt(5) lgkmcnt(4)
    v_mfma_f32_32x32x16_bf16 v[64:79], v[144:147], a[104:107], v[64:79]
    s_add_u32 s53, s7, 7
    s_and_b32 s53, s53, 7
    s_lshl_b32 s53, s53, 13
    v_add_u32 v20, s53, v2
    v_add_u32 v21, s53, v3
    ds_read_b64_tr_b16 v[136:137], v20 offset:0
    ds_read_b64_tr_b16 v[138:139], v20 offset:1024
    v_mfma_f32_32x32x16_bf16 v[80:95], v[148:151], a[104:107], v[80:95]
    ds_read_b64_tr_b16 v[140:141], v21 offset:0
    ds_read_b64_tr_b16 v[142:143], v21 offset:1024
    s_waitcnt vmcnt(4) lgkmcnt(4)
    v_mfma_f32_32x32x16_bf16 v[64:79], v[128:131], a[108:111], v[64:79]
    ds_read_b64_tr_b16 v[144:145], v20 offset:2048
    ds_read_b64_tr_b16 v[146:147], v20 offset:3072
    v_mfma_f32_32x32x16_bf16 v[80:95], v[132:135], a[108:111], v[80:95]
    ds_read_b64_tr_b16 v[148:149], v21 offset:2048
    ds_read_b64_tr_b16 v[150:151], v21 offset:3072
    s_waitcnt vmcnt(3) lgkmcnt(4)
    v_mfma_f32_32x32x16_bf16 v[64:79], v[136:139], a[112:115], v[64:79]
    ds_read_b64_tr_b16 v[128:129], v20 offset:4096
    ds_read_b64_tr_b16 v[130:131], v20 offset:5120
    v_mfma_f32_32x32x16_bf16 v[80:95], v[140:143], a[112:115], v[80:95]
    ds_read_b64_tr_b16 v[132:133], v21 offset:4096
    ds_read_b64_tr_b16 v[134:135], v21 offset:5120
    s_waitcnt vmcnt(2) lgkmcnt(4)
    v_mfma_f32_32x32x16_bf16 v[64:79], v[144:147], a[116:119], v[64:79]
    ds_read_b64_tr_b16 v[136:137], v20 offset:6144
    ds_read_b64_tr_b16 v[138:139], v20 offset:7168
    v_mfma_f32_32x32x16_bf16 v[80:95], v[148:151], a[116:119], v[80:95]
    ds_read_b64_tr_b16 v[140:141], v21 offset:6144
    ds_read_b64_tr_b16 v[142:143], v21 offset:7168
    s_waitcnt vmcnt(1) lgkmcnt(4)
    v_mfma_f32_32x32x16_bf16 v[64:79], v[128:131], a[120:123], v[64:79]
    v_mfma_f32_32x32x16_bf16 v[80:95], v[132:135], a[120:123], v[80:95]
    s_waitcnt vmcnt(0) lgkmcnt(0)
    v_mfma_f32_32x32x16_bf16 v[64:79], v[136:139], a[124:127], v[64:79]
    v_mfma_f32_32x32x16_bf16 v[80:95], v[140:143], a[124:127], v[80:95]
    s_nop 10
    v_pk_mul_f32 v[64:65], v[64:65], v[96:97] op_sel_hi:[1,0]
    v_pk_mul_f32 v[66:67], v[66:67], v[96:97] op_sel_hi:[1,0]
    ds_write_b128 v4, v[64:67] offset:0
    v_pk_mul_f32 v[68:69], v[68:69], v[96:97] op_sel_hi:[1,0]
    v_pk_mul_f32 v[70:71], v[70:71], v[96:97] op_sel_hi:[1,0]
    ds_write_b128 v5, v[68:71] offset:0
    v_pk_mul_f32 v[72:73], v[72:73], v[96:97] op_sel_hi:[1,0]
    v_pk_mul_f32 v[74:75], v[74:75], v[96:97] op_sel_hi:[1,0]
    ds_write_b128 v6, v[72:75] offset:0
    v_pk_mul_f32 v[76:77], v[76:77], v[96:97] op_sel_hi:[1,0]
    v_pk_mul_f32 v[78:79], v[78:79], v[96:97] op_sel_hi:[1,0]
    ds_write_b128 v7, v[76:79] offset:0
    v_pk_mul_f32 v[80:81], v[80:81], v[96:97] op_sel_hi:[1,0]
    v_pk_mul_f32 v[82:83], v[82:83], v[96:97] op_sel_hi:[1,0]
    ds_write_b128 v4, v[80:83] offset:128
    v_pk_mul_f32 v[84:85], v[84:85], v[96:97] op_sel_hi:[1,0]
    v_pk_mul_f32 v[86:87], v[86:87], v[96:97] op_sel_hi:[1,0]
    ds_write_b128 v5, v[84:87] offset:128
    v_pk_mul_f32 v[88:89], v[88:89], v[96:97] op_sel_hi:[1,0]
    v_pk_mul_f32 v[90:91], v[90:91], v[96:97] op_sel_hi:[1,0]
    ds_write_b128 v6, v[88:91] offset:128
    v_pk_mul_f32 v[92:93], v[92:93], v[96:97] op_sel_hi:[1,0]
    v_pk_mul_f32 v[94:95], v[94:95], v[96:97] op_sel_hi:[1,0]
    ds_write_b128 v7, v[92:95] offset:128
    s_waitcnt lgkmcnt(0)
    s_barrier
    ds_read_b128 v[168:171], v8 offset:0
    ds_read_b128 v[172:175], v9 offset:0
    ds_read_b128 v[176:179], v8 offset:16384
    ds_read_b128 v[180:183], v9 offset:16384
    ds_read_b128 v[184:187], v8 offset:2048
    ds_read_b128 v[188:191], v9 offset:2048
    ds_read_b128 v[192:195], v8 offset:18432
    ds_read_b128 v[196:199], v9 offset:18432
    s_waitcnt lgkmcnt(4)
    v_pk_add_f32 v[168:169], v[168:169], v[176:177]
    v_pk_add_f32 v[170:171], v[170:171], v[178:179]
    v_pk_add_f32 v[172:173], v[172:173], v[180:181]
    v_pk_add_f32 v[174:175], v[174:175], v[182:183]
    v_cvt_pk_bf16_f32 v176, v168, v169
    v_cvt_pk_bf16_f32 v177, v170, v171
    v_cvt_pk_bf16_f32 v178, v172, v173
    v_cvt_pk_bf16_f32 v179, v174, v175
    buffer_store_dwordx4 v[176:179], v14, s[28:31], s50 offen
    s_waitcnt lgkmcnt(0)
    v_pk_add_f32 v[184:185], v[184:185], v[192:193]
    v_pk_add_f32 v[186:187], v[186:187], v[194:195]
    v_pk_add_f32 v[188:189], v[188:189], v[196:197]
    v_pk_add_f32 v[190:191], v[190:191], v[198:199]
    v_cvt_pk_bf16_f32 v192, v184, v185
    v_cvt_pk_bf16_f32 v193, v186, v187
    v_cvt_pk_bf16_f32 v194, v188, v189
    v_cvt_pk_bf16_f32 v195, v190, v191
    buffer_store_dwordx4 v[192:195], v14, s[28:31], s51 offen
    s_cmp_eq_u32 s92, 0
    s_cbranch_scc0 L_noepA
    s_cmp_eq_u32 s40, 0
    s_cbranch_scc0 L_noepA
    v_mov_b32 v27, 0
    s_mov_b64 exec, 1
    buffer_store_dword v26, v27, s[24:27], 0 offen sc1
    s_mov_b64 exec, -1
L_noepA:
    s_endpgm
L_pathB:
    v_lshrrev_b32 v27, 6, v0
    v_and_b32 v1, 63, v0
    v_readfirstlane_b32 s40, v27
    v_lshrrev_b32 v27, 3, v1
    v_and_b32 v28, 7, v1
    v_lshrrev_b32 v29, 4, v1
    v_add_u32 v30, 0, v29
    v_xor_b32 v30, v28, v30
    v_lshlrev_b32 v30, 4, v30
    v_add_u32 v31, 0, v27
    v_lshl_add_u32 v17, v31, 10, v30
    v_add_u32 v30, 4, v29
    v_xor_b32 v30, v28, v30
    v_lshlrev_b32 v30, 4, v30
    v_add_u32 v31, 7, v27
    v_lshl_add_u32 v18, v31, 10, v30
    v_add_u32 v19, 14336, v17
    v_add_u32 v20, 14336, v18
    v_and_b32 v30, 1, v29
    v_lshlrev_b32 v30, 2, v30
    v_xor_b32 v30, v28, v30
    v_lshlrev_b32 v30, 4, v30
    v_mul_u32_u24 v31, 3072, v27
    v_add_u32 v21, v30, v31
    v_add_u32 v22, 23552, v21
    v_add_u32 v23, 47104, v21
    v_add_u32 v24, 70656, v21
    s_and_b32 s41, s40, 1
    s_lshr_b32 s42, s40, 1
    s_lshl_b32 s47, s43, 17
    s_lshl_b32 s53, s40, 15
    s_add_u32 s47, s47, s53
    s_lshl_b32 s60, s44, 7
    s_mul_i32 s53, s41, 98304
    s_add_u32 s48, s60, s53
    s_add_u32 s53, s42, 1
    s_lshl_b32 s53, s53, 10
    s_add_u32 s48, s48, s53
    s_lshl_b32 s49, s40, 12
    s_lshl_b32 s50, s42, 13
    s_lshl_b32 s53, s41, 12
    s_add_u32 s50, s50, s53
    s_add_u32 s50, s50, 16384
    s_lshl_b32 s61, s40, 11
    s_mul_i32 s53, s40, 49152
    s_add_u32 s53, s53, s60
    s_sub_u32 s4, s48, s53
    s_add_u32 s53, s45, 0
    s_and_b32 s53, s53, 7
    s_lshl_b32 s54, s53, 7
    s_add_u32 s51, s47, s54
    s_mul_i32 s54, s53, 196608
    s_add_u32 s52, s48, s54
    s_sub_u32 s5, s52, s4
    s_waitcnt lgkmcnt(0)
    s_mov_b32 s8, s64
    s_and_b32 s9, s65, 0xffff
    s_mov_b32 s10, 0x200000
    s_mov_b32 s11, 0x00020000
    s_mov_b32 s12, s72
    s_and_b32 s13, s73, 0xffff
    s_mov_b32 s14, 0x180000
    s_mov_b32 s15, 0x00020000
    s_add_u32 m0, s49, 0
    s_nop 0
    buffer_load_dwordx4 v17, s[8:11], s51 offen lds
    buffer_load_dwordx4 v18, s[8:11], s51 offen offset:1024 lds
    buffer_load_dwordx4 v19, s[8:11], s51 offen offset:2048 lds
    buffer_load_dwordx4 v20, s[8:11], s51 offen offset:3072 lds
    s_add_u32 m0, s50, 0
    s_nop 0
    buffer_load_dwordx4 v21, s[12:15], s52 offen lds
    buffer_load_dwordx4 v22, s[12:15], s52 offen offset:1024 lds
    buffer_load_dwordx4 v23, s[12:15], s52 offen offset:2048 lds
    buffer_load_dwordx4 v24, s[12:15], s52 offen offset:3072 lds
    s_getpc_b64 s[98:99]
L_pcB:
    s_sub_u32 s98, s98, L_pcB-gated_mix__linear_attn_block__linear_kernel_hedgehog__prompt_kernel
    s_subb_u32 s99, s99, 0
    s_lshr_b32 s53, s92, 3
    s_lshl_b32 s53, s53, 2
    s_add_u32 s53, s53, s40
    s_lshl_b32 s53, s53, 9
    v_lshlrev_b32 v27, 7, v1
    v_and_b32 v27, 0x1ff, v27
    v_add_u32 v27, s53, v27
    v_min_u32 v27, L_end-gated_mix__linear_attn_block__linear_kernel_hedgehog__prompt_kernel, v27
    v_mov_b32 v29, s99
    v_add_co_u32 v28, vcc, s98, v27
    s_nop 1
    v_addc_co_u32 v29, vcc, 0, v29, vcc
    s_mov_b64 exec, 15
    global_load_dword v239, v[28:29], off
    s_mov_b64 exec, -1
    s_mov_b32 s24, s82
    s_and_b32 s25, s83, 0xffff
    s_mov_b32 s26, 0x1000000
    s_mov_b32 s27, 0x00020000
    s_mov_b32 s32, s74
    s_and_b32 s33, s75, 0xffff
    s_mov_b32 s34, 0x4000
    s_mov_b32 s35, 0x00020000
    s_lshl_b32 s53, s44, 11
    s_lshl_b32 s54, s42, 10
    s_add_u32 s53, s53, s54
    s_lshl_b32 s54, s40, 10
    s_add_u32 m0, s54, 131072
    v_lshlrev_b32 v27, 4, v1
    buffer_load_dwordx4 v27, s[32:35], s53 offen lds
    v_mov_b32 v28, 0
    buffer_load_dword v26, v28, s[24:27], 0 offen sc1
    s_mov_b32 s16, s68
    s_and_b32 s17, s69, 0xffff
    s_mov_b32 s18, 0x80000
    s_mov_b32 s19, 0x00020000
    s_mov_b32 s20, s76
    s_and_b32 s21, s77, 0xffff
    s_mov_b32 s22, 0x80000
    s_mov_b32 s23, 0x00020000
    s_mov_b32 s28, s80
    s_and_b32 s29, s81, 0xffff
    s_mov_b32 s30, 0x200000
    s_mov_b32 s31, 0x00020000
    s_add_u32 s53, s45, 2
    s_and_b32 s53, s53, 7
    s_lshl_b32 s54, s53, 7
    s_add_u32 s66, s47, s54
    s_mul_i32 s54, s53, 196608
    s_add_u32 s67, s48, s54
    s_add_u32 s53, s45, 4
    s_and_b32 s53, s53, 7
    s_lshl_b32 s54, s53, 7
    s_add_u32 s68, s47, s54
    s_mul_i32 s54, s53, 196608
    s_add_u32 s69, s48, s54
    s_add_u32 s53, s45, 6
    s_and_b32 s53, s53, 7
    s_lshl_b32 s54, s53, 7
    s_add_u32 s70, s47, s54
    s_mul_i32 s54, s53, 196608
    s_add_u32 s71, s48, s54
    s_add_u32 s53, s45, 1
    s_and_b32 s53, s53, 7
    s_lshl_b32 s54, s53, 7
    s_add_u32 s72, s47, s54
    s_mul_i32 s54, s53, 196608
    s_add_u32 s73, s48, s54
    s_add_u32 s53, s45, 3
    s_and_b32 s53, s53, 7
    s_lshl_b32 s54, s53, 7
    s_add_u32 s74, s47, s54
    s_mul_i32 s54, s53, 196608
    s_add_u32 s75, s48, s54
    s_add_u32 s53, s45, 5
    s_and_b32 s53, s53, 7
    s_lshl_b32 s54, s53, 7
    s_add_u32 s76, s47, s54
    s_mul_i32 s54, s53, 196608
    s_add_u32 s77, s48, s54
    s_add_u32 s53, s45, 7
    s_and_b32 s53, s53, 7
    s_lshl_b32 s54, s53, 7
    s_add_u32 s78, s47, s54
    s_mul_i32 s54, s53, 196608
    s_add_u32 s79, s48, s54
    s_lshl_b32 s53, s44, 18
    s_add_u32 s53, s53, 10485760
    buffer_load_dword v232, v28, s[24:27], s53 offen
    s_lshl_b32 s53, s43, 18
    s_add_u32 s53, s53, 2097152
    buffer_load_dword v233, v28, s[24:27], s53 offen
    s_lshl_b32 s53, s57, 17
    s_add_u32 s53, s53, 2097152
    buffer_load_dword v234, v28, s[24:27], s53 offen
    buffer_load_dword v235, v28, s[16:19], 0 offen
    buffer_load_dword v236, v28, s[20:23], 0 offen
    s_lshl_b32 s53, s57, 16
    buffer_load_dword v237, v28, s[28:31], s53 offen
    v_lshrrev_b32 v27, 3, v1
    v_and_b32 v28, 7, v1
    v_bfe_u32 v29, v1, 4, 1
    v_lshlrev_b32 v29, 2, v29
    v_xor_b32 v28, v28, v29
    v_lshlrev_b32 v28, 4, v28
    s_lshl_b32 s53, s58, 7
    v_add_u32 v28, s53, v28
    v_lshl_add_u32 v10, v27, 10, v28
    v_add_u32 v11, 7168, v10
    v_add_u32 v12, 14336, v10
    v_add_u32 v13, 21504, v10
    s_lshl_b32 s96, s40, 16
    s_lshl_b32 s97, s40, 13
    s_and_b32 s6, s57, 3
    s_lshr_b32 s53, s6, 1
    s_lshl_b32 s53, s53, 18
    s_add_u32 s96, s96, s53
    s_bitcmp1_b32 s6, 0
    s_cselect_b32 s53, s20, s16
    s_cselect_b32 s54, s16, s20
    s_cselect_b32 s98, s21, s17
    s_cselect_b32 s99, s17, s21
    s_mov_b32 s16, s53
    s_mov_b32 s20, s54
    s_mov_b32 s17, s98
    s_mov_b32 s21, s99
    v_and_b32 v27, 31, v1
    v_lshrrev_b32 v28, 5, v1
    v_lshrrev_b32 v29, 1, v27
    v_and_b32 v29, 7, v29
    v_xor_b32 v29, v28, v29
    s_lshl_b32 s53, s41, 13
    v_lshlrev_b32 v30, 7, v27
    v_add_u32 v30, s53, v30
    v_xor_b32 v31, 0, v29
    v_lshl_add_u32 v2, v31, 4, v30
    v_add_u32 v6, 0x10000, v2
    v_xor_b32 v31, 2, v29
    v_lshl_add_u32 v3, v31, 4, v30
    v_add_u32 v7, 0x10000, v3
    v_xor_b32 v31, 4, v29
    v_lshl_add_u32 v4, v31, 4, v30
    v_add_u32 v8, 0x10000, v4
    v_xor_b32 v31, 6, v29
    v_lshl_add_u32 v5, v31, 4, v30
    v_add_u32 v9, 0x10000, v5
    v_lshrrev_b32 v27, 2, v1
    v_and_b32 v27, 3, v27
    v_lshl_add_u32 v29, v28, 3, v27
    v_lshlrev_b32 v29, 7, v29
    v_lshrrev_b32 v30, 1, v27
    v_xor_b32 v30, s42, v30
    v_lshl_add_u32 v29, v30, 6, v29
    v_lshrrev_b32 v30, 4, v1
    v_xor_b32 v30, s41, v30
    v_and_b32 v30, 1, v30
    v_lshl_add_u32 v29, v30, 5, v29
    v_and_b32 v30, 3, v1
    v_lshl_add_u32 v14, v30, 3, v29
    v_add_u32 v15, 0x10000, v14
    v_add_u32 v16, 0x20000, v14
    v_mov_b32 v25, 0x3f803f80
    s_mov_b32 s62, 0xffff0000
    s_mov_b32 s63, 0xffff0000
    s_mov_b32 s84, 0x3fb8aa3b
    s_mov_b32 s85, 0x3fb8aa3b
    s_mov_b32 s86, 0x358637bd
    s_mov_b32 s87, 0x358637bd
    v_and_b32 v27, 31, v1
    v_lshrrev_b32 v28, 5, v1
    v_bfe_u32 v29, v27, 2, 1
    v_cmp_eq_u32 vcc, v28, v29
    v_bfe_u32 v29, v27, 3, 1
    v_and_b32 v30, 3, v27
    v_lshl_add_u32 v29, v29, 2, v30
    v_and_b32 v30, 1, v29
    v_lshlrev_b32 v30, 4, v30
    v_mov_b32 v31, 0x3f80
    v_lshlrev_b32 v30, v30, v31
    v_cndmask_b32 v30, 0, v30, vcc
    v_lshrrev_b32 v29, 1, v29
    v_bfe_u32 v28, v27, 4, 1
    v_lshl_add_u32 v29, v28, 2, v29
    v_cmp_eq_u32 vcc, 0, v29
    s_nop 1
    v_cndmask_b32 v160, 0, v30, vcc
    v_cmp_eq_u32 vcc, 1, v29
    s_nop 1
    v_cndmask_b32 v161, 0, v30, vcc
    v_cmp_eq_u32 vcc, 2, v29
    s_nop 1
    v_cndmask_b32 v162, 0, v30, vcc
    v_cmp_eq_u32 vcc, 3, v29
    s_nop 1
    v_cndmask_b32 v163, 0, v30, vcc
    v_cmp_eq_u32 vcc, 4, v29
    s_nop 1
    v_cndmask_b32 v164, 0, v30, vcc
    v_cmp_eq_u32 vcc, 5, v29
    s_nop 1
    v_cndmask_b32 v165, 0, v30, vcc
    v_cmp_eq_u32 vcc, 6, v29
    s_nop 1
    v_cndmask_b32 v166, 0, v30, vcc
    v_cmp_eq_u32 vcc, 7, v29
    s_nop 1
    v_cndmask_b32 v167, 0, v30, vcc
    s_mov_b32 s94, 0xaaaaaaaa
    s_mov_b32 s95, 0xaaaaaaaa
    v_lshrrev_b32 v27, 5, v1
    v_lshlrev_b32 v27, 2, v27
    v_bfe_u32 v28, v1, 2, 2
    v_add_u32 v27, v27, v28
    v_lshlrev_b32 v27, 5, v27
    v_bfe_u32 v28, v1, 1, 1
    v_lshl_add_u32 v27, v28, 3, v27
    v_bfe_u32 v28, v1, 4, 1
    v_lshl_add_u32 v27, v28, 4, v27
    s_lshl_b32 s53, s40, 10
    s_add_u32 s53, s53, 131072
    s_lshl_b32 s54, s41, 9
    s_add_u32 s53, s53, s54
    v_add_u32 v27, s53, v27
    v_xor_b32 v29, 512, v27
    v_bfe_u32 v28, v1, 2, 1
    v_lshlrev_b32 v28, 31, v28
    v_lshrrev_b32 v30, 16, v28
    v_or_b32 v28, v28, v30
    s_add_u32 m0, s49, 32768
    s_nop 0
    buffer_load_dwordx4 v17, s[8:11], s66 offen lds
    buffer_load_dwordx4 v18, s[8:11], s66 offen offset:1024 lds
    buffer_load_dwordx4 v19, s[8:11], s66 offen offset:2048 lds
    buffer_load_dwordx4 v20, s[8:11], s66 offen offset:3072 lds
    s_add_u32 m0, s50, 32768
    s_nop 0
    buffer_load_dwordx4 v21, s[12:15], s67 offen lds
    buffer_load_dwordx4 v22, s[12:15], s67 offen offset:1024 lds
    buffer_load_dwordx4 v23, s[12:15], s67 offen offset:2048 lds
    buffer_load_dwordx4 v24, s[12:15], s67 offen offset:3072 lds
    s_waitcnt vmcnt(15)
    ds_read_b64_tr_b16 v[152:153], v27 offset:0
    ds_read_b64_tr_b16 v[154:155], v27 offset:256
    ds_read_b64_tr_b16 v[156:157], v29 offset:0
    ds_read_b64_tr_b16 v[158:159], v29 offset:256
    s_waitcnt lgkmcnt(0)
    v_xor_b32 v152, v152, v28
    v_xor_b32 v153, v153, v28
    v_xor_b32 v154, v154, v28
    v_xor_b32 v155, v155, v28
    v_xor_b32 v156, v156, v28
    v_xor_b32 v157, v157, v28
    v_xor_b32 v158, v158, v28
    v_xor_b32 v159, v159, v28
    s_barrier
    ds_read_b64_tr_b16 v[128:129], v14 offset:16384
    ds_read_b64_tr_b16 v[130:131], v14 offset:16896
    ds_read_b64_tr_b16 v[132:133], v14 offset:24576
    ds_read_b64_tr_b16 v[134:135], v14 offset:25088
    ds_read_b128 a[0:3], v2 offset:0
    ds_read_b128 a[4:7], v2 offset:4096
    ds_read_b64_tr_b16 v[136:137], v14 offset:18432
    ds_read_b64_tr_b16 v[138:139], v14 offset:18944
    ds_read_b64_tr_b16 v[140:141], v14 offset:26624
    ds_read_b64_tr_b16 v[142:143], v14 offset:27136
    ds_read_b128 a[8:11], v3 offset:0
    ds_read_b128 a[12:15], v3 offset:4096
    s_waitcnt lgkmcnt(6)
    v_mfma_f32_32x32x16_bf16 v[32:47], v[128:131], a[0:3], 0
    ds_read_b64_tr_b16 v[144:145], v14 offset:20480
    v_mfma_f32_32x32x16_bf16 v[64:79], a[0:3], v[132:135], 0
    ds_read_b64_tr_b16 v[146:147], v14 offset:20992
    ds_read_b64_tr_b16 v[148:149], v14 offset:28672
    s_add_u32 m0, s49, 65536
    s_nop 0
    buffer_load_dwordx4 v17, s[8:11], s68 offen lds
    v_mfma_f32_32x32x16_bf16 v[48:63], v[128:131], a[4:7], 0
    ds_read_b64_tr_b16 v[150:151], v14 offset:29184
    v_mfma_f32_32x32x16_bf16 v[80:95], a[4:7], v[132:135], 0
    ds_read_b128 a[16:19], v4 offset:0
    ds_read_b128 a[20:23], v4 offset:4096
    buffer_load_dwordx4 v18, s[8:11], s68 offen offset:1024 lds
    s_waitcnt lgkmcnt(6)
    v_mfma_f32_32x32x16_bf16 v[32:47], v[136:139], a[8:11], v[32:47]
    ds_read_b64_tr_b16 v[128:129], v14 offset:22528
    v_mfma_f32_32x32x16_bf16 v[64:79], a[8:11], v[140:143], v[64:79]
    ds_read_b64_tr_b16 v[130:131], v14 offset:23040
    ds_read_b64_tr_b16 v[132:133], v14 offset:30720
    buffer_load_dwordx4 v19, s[8:11], s68 offen offset:2048 lds
    v_mfma_f32_32x32x16_bf16 v[48:63], v[136:139], a[12:15], v[48:63]
    ds_read_b64_tr_b16 v[134:135], v14 offset:31232
    v_mfma_f32_32x32x16_bf16 v[80:95], a[12:15], v[140:143], v[80:95]
    ds_read_b128 a[24:27], v5 offset:0
    ds_read_b128 a[28:31], v5 offset:4096
    buffer_load_dwordx4 v20, s[8:11], s68 offen offset:3072 lds
    s_waitcnt lgkmcnt(6)
    v_mfma_f32_32x32x16_bf16 v[32:47], v[144:147], a[16:19], v[32:47]
    s_waitcnt vmcnt(4)
    s_barrier
    ds_read_b64_tr_b16 v[136:137], v14 offset:49152
    s_add_u32 m0, s50, 65536
    s_nop 0
    buffer_load_dwordx4 v21, s[12:15], s69 offen lds
    v_mfma_f32_32x32x16_bf16 v[64:79], a[16:19], v[148:151], v[64:79]
    ds_read_b64_tr_b16 v[138:139], v14 offset:49664
    ds_read_b64_tr_b16 v[140:141], v14 offset:57344
    buffer_load_dwordx4 v22, s[12:15], s69 offen offset:1024 lds
    v_mfma_f32_32x32x16_bf16 v[48:63], v[144:147], a[20:23], v[48:63]
    ds_read_b64_tr_b16 v[142:143], v14 offset:57856
    buffer_load_dwordx4 v23, s[12:15], s69 offen offset:2048 lds
    v_mfma_f32_32x32x16_bf16 v[80:95], a[20:23], v[148:151], v[80:95]
    ds_read_b128 a[32:35], v2 offset:32768
    ds_read_b128 a[36:39], v2 offset:36864
    buffer_load_dwordx4 v24, s[12:15], s69 offen offset:3072 lds
    s_waitcnt lgkmcnt(6)
    v_mfma_f32_32x32x16_bf16 v[32:47], v[128:131], a[24:27], v[32:47]
    ds_read_b64_tr_b16 v[144:145], v14 offset:51200
    v_mfma_f32_32x32x16_bf16 v[64:79], a[24:27], v[132:135], v[64:79]
    ds_read_b64_tr_b16 v[146:147], v14 offset:51712
    ds_read_b64_tr_b16 v[148:149], v14 offset:59392
    s_add_u32 m0, s49, 98304
    s_nop 0
    buffer_load_dwordx4 v17, s[8:11], s70 offen lds
    v_mfma_f32_32x32x16_bf16 v[48:63], v[128:131], a[28:31], v[48:63]
    ds_read_b64_tr_b16 v[150:151], v14 offset:59904
    v_mfma_f32_32x32x16_bf16 v[80:95], a[28:31], v[132:135], v[80:95]
    ds_read_b128 a[40:43], v3 offset:32768
    ds_read_b128 a[44:47], v3 offset:36864
    buffer_load_dwordx4 v18, s[8:11], s70 offen offset:1024 lds
    s_waitcnt lgkmcnt(6)
    v_mfma_f32_32x32x16_bf16 v[32:47], v[136:139], a[32:35], v[32:47]
    ds_read_b64_tr_b16 v[128:129], v14 offset:53248
    v_mfma_f32_32x32x16_bf16 v[64:79], a[32:35], v[140:143], v[64:79]
    ds_read_b64_tr_b16 v[130:131], v14 offset:53760
    ds_read_b64_tr_b16 v[132:133], v14 offset:61440
    buffer_load_dwordx4 v19, s[8:11], s70 offen offset:2048 lds
    v_mfma_f32_32x32x16_bf16 v[48:63], v[136:139], a[36:39], v[48:63]
    ds_read_b64_tr_b16 v[134:135], v14 offset:61952
    v_mfma_f32_32x32x16_bf16 v[80:95], a[36:39], v[140:143], v[80:95]
    ds_read_b128 a[48:51], v4 offset:32768
    ds_read_b128 a[52:55], v4 offset:36864
    buffer_load_dwordx4 v20, s[8:11], s70 offen offset:3072 lds
    s_waitcnt lgkmcnt(6)
    v_mfma_f32_32x32x16_bf16 v[32:47], v[144:147], a[40:43], v[32:47]
    ds_read_b64_tr_b16 v[136:137], v14 offset:55296
    v_mfma_f32_32x32x16_bf16 v[64:79], a[40:43], v[148:151], v[64:79]
    ds_read_b64_tr_b16 v[138:139], v14 offset:55808
    ds_read_b64_tr_b16 v[140:141], v14 offset:63488
    s_add_u32 m0, s50, 98304
    s_nop 0
    buffer_load_dwordx4 v21, s[12:15], s71 offen lds
    v_mfma_f32_32x32x16_bf16 v[48:63], v[144:147], a[44:47], v[48:63]
    ds_read_b64_tr_b16 v[142:143], v14 offset:64000
    v_mfma_f32_32x32x16_bf16 v[80:95], a[44:47], v[148:151], v[80:95]
    ds_read_b128 a[56:59], v5 offset:32768
    ds_read_b128 a[60:63], v5 offset:36864
    buffer_load_dwordx4 v22, s[12:15], s71 offen offset:1024 lds
    s_waitcnt lgkmcnt(6)
    v_mfma_f32_32x32x16_bf16 v[32:47], v[128:131], a[48:51], v[32:47]
    s_waitcnt vmcnt(6)
    s_barrier
    ds_read_b64_tr_b16 v[144:145], v15 offset:16384
    buffer_load_dwordx4 v23, s[12:15], s71 offen offset:2048 lds
    v_mfma_f32_32x32x16_bf16 v[64:79], a[48:51], v[132:135], v[64:79]
    ds_read_b64_tr_b16 v[146:147], v15 offset:16896
    ds_read_b64_tr_b16 v[148:149], v15 offset:24576
    buffer_load_dwordx4 v24, s[12:15], s71 offen offset:3072 lds
    v_mfma_f32_32x32x16_bf16 v[48:63], v[128:131], a[52:55], v[48:63]
    ds_read_b64_tr_b16 v[150:151], v15 offset:25088
    v_mfma_f32_32x32x16_bf16 v[80:95], a[52:55], v[132:135], v[80:95]
    ds_read_b128 a[64:67], v6 offset:0
    ds_read_b128 a[68:71], v6 offset:4096
    s_add_u32 m0, s49, 0
    s_nop 0
    buffer_load_dwordx4 v17, s[8:11], s72 offen lds
    s_waitcnt lgkmcnt(6)
    v_mfma_f32_32x32x16_bf16 v[32:47], v[136:139], a[56:59], v[32:47]
    ds_read_b64_tr_b16 v[128:129], v15 offset:18432
    v_mfma_f32_32x32x16_bf16 v[64:79], a[56:59], v[140:143], v[64:79]
    ds_read_b64_tr_b16 v[130:131], v15 offset:18944
    ds_read_b64_tr_b16 v[132:133], v15 offset:26624
    buffer_load_dwordx4 v18, s[8:11], s72 offen offset:1024 lds
    v_mfma_f32_32x32x16_bf16 v[48:63], v[136:139], a[60:63], v[48:63]
    ds_read_b64_tr_b16 v[134:135], v15 offset:27136
    v_mfma_f32_32x32x16_bf16 v[80:95], a[60:63], v[140:143], v[80:95]
    ds_read_b128 a[72:75], v7 offset:0
    ds_read_b128 a[76:79], v7 offset:4096
    buffer_load_dwordx4 v19, s[8:11], s72 offen offset:2048 lds
    s_waitcnt lgkmcnt(6)
    v_mfma_f32_32x32x16_bf16 v[32:47], v[144:147], a[64:67], v[32:47]
    ds_read_b64_tr_b16 v[136:137], v15 offset:20480
    v_mfma_f32_32x32x16_bf16 v[64:79], a[64:67], v[148:151], v[64:79]
    ds_read_b64_tr_b16 v[138:139], v15 offset:20992
    ds_read_b64_tr_b16 v[140:141], v15 offset:28672
    buffer_load_dwordx4 v20, s[8:11], s72 offen offset:3072 lds
    v_mfma_f32_32x32x16_bf16 v[48:63], v[144:147], a[68:71], v[48:63]
    ds_read_b64_tr_b16 v[142:143], v15 offset:29184
    v_mfma_f32_32x32x16_bf16 v[80:95], a[68:71], v[148:151], v[80:95]
    ds_read_b128 a[80:83], v8 offset:0
    ds_read_b128 a[84:87], v8 offset:4096
    s_add_u32 m0, s50, 0
    s_nop 0
    buffer_load_dwordx4 v21, s[12:15], s73 offen lds
    s_waitcnt lgkmcnt(6)
    v_mfma_f32_32x32x16_bf16 v[32:47], v[128:131], a[72:75], v[32:47]
    ds_read_b64_tr_b16 v[144:145], v15 offset:22528
    v_mfma_f32_32x32x16_bf16 v[64:79], a[72:75], v[132:135], v[64:79]
    ds_read_b64_tr_b16 v[146:147], v15 offset:23040
    ds_read_b64_tr_b16 v[148:149], v15 offset:30720
    buffer_load_dwordx4 v22, s[12:15], s73 offen offset:1024 lds
    v_mfma_f32_32x32x16_bf16 v[48:63], v[128:131], a[76:79], v[48:63]
    ds_read_b64_tr_b16 v[150:151], v15 offset:31232
    v_mfma_f32_32x32x16_bf16 v[80:95], a[76:79], v[132:135], v[80:95]
    ds_read_b128 a[88:91], v9 offset:0
    ds_read_b128 a[92:95], v9 offset:4096
    buffer_load_dwordx4 v23, s[12:15], s73 offen offset:2048 lds
    s_waitcnt lgkmcnt(6)
    v_mfma_f32_32x32x16_bf16 v[32:47], v[136:139], a[80:83], v[32:47]
    s_waitcnt vmcnt(7)
    s_barrier
    ds_read_b64_tr_b16 v[128:129], v15 offset:49152
    buffer_load_dwordx4 v24, s[12:15], s73 offen offset:3072 lds
    v_mfma_f32_32x32x16_bf16 v[64:79], a[80:83], v[140:143], v[64:79]
    ds_read_b64_tr_b16 v[130:131], v15 offset:49664
    ds_read_b64_tr_b16 v[132:133], v15 offset:57344
    s_add_u32 m0, s49, 32768
    s_nop 0
    buffer_load_dwordx4 v17, s[8:11], s74 offen lds
    v_mfma_f32_32x32x16_bf16 v[48:63], v[136:139], a[84:87], v[48:63]
    ds_read_b64_tr_b16 v[134:135], v15 offset:57856
    v_mfma_f32_32x32x16_bf16 v[80:95], a[84:87], v[140:143], v[80:95]
    ds_read_b128 a[96:99], v6 offset:32768
    ds_read_b128 a[100:103], v6 offset:36864
    buffer_load_dwordx4 v18, s[8:11], s74 offen offset:1024 lds
    s_waitcnt lgkmcnt(6)
    v_mfma_f32_32x32x16_bf16 v[32:47], v[144:147], a[88:91], v[32:47]
    ds_read_b64_tr_b16 v[136:137], v15 offset:51200
    v_mfma_f32_32x32x16_bf16 v[64:79], a[88:91], v[148:151], v[64:79]
    ds_read_b64_tr_b16 v[138:139], v15 offset:51712
    ds_read_b64_tr_b16 v[140:141], v15 offset:59392
    buffer_load_dwordx4 v19, s[8:11], s74 offen offset:2048 lds
    v_mfma_f32_32x32x16_bf16 v[48:63], v[144:147], a[92:95], v[48:63]
    ds_read_b64_tr_b16 v[142:143], v15 offset:59904
    v_mfma_f32_32x32x16_bf16 v[80:95], a[92:95], v[148:151], v[80:95]
    ds_read_b128 a[104:107], v7 offset:32768
    ds_read_b128 a[108:111], v7 offset:36864
    buffer_load_dwordx4 v20, s[8:11], s74 offen offset:3072 lds
    s_waitcnt lgkmcnt(6)
    v_mfma_f32_32x32x16_bf16 v[32:47], v[128:131], a[96:99], v[32:47]
    ds_read_b64_tr_b16 v[144:145], v15 offset:53248
    v_mfma_f32_32x32x16_bf16 v[64:79], a[96:99], v[132:135], v[64:79]
    ds_read_b64_tr_b16 v[146:147], v15 offset:53760
    ds_read_b64_tr_b16 v[148:149], v15 offset:61440
    s_add_u32 m0, s50, 32768
    s_nop 0
    buffer_load_dwordx4 v21, s[12:15], s75 offen lds
    v_mfma_f32_32x32x16_bf16 v[48:63], v[128:131], a[100:103], v[48:63]
    ds_read_b64_tr_b16 v[150:151], v15 offset:61952
    v_mfma_f32_32x32x16_bf16 v[80:95], a[100:103], v[132:135], v[80:95]
    ds_read_b128 a[112:115], v8 offset:32768
    ds_read_b128 a[116:119], v8 offset:36864
    buffer_load_dwordx4 v22, s[12:15], s75 offen offset:1024 lds
    s_waitcnt lgkmcnt(6)
    v_mfma_f32_32x32x16_bf16 v[32:47], v[136:139], a[104:107], v[32:47]
    ds_read_b64_tr_b16 v[128:129], v15 offset:55296
    v_mfma_f32_32x32x16_bf16 v[64:79], a[104:107], v[140:143], v[64:79]
    ds_read_b64_tr_b16 v[130:131], v15 offset:55808
    ds_read_b64_tr_b16 v[132:133], v15 offset:63488
    buffer_load_dwordx4 v23, s[12:15], s75 offen offset:2048 lds
    v_mfma_f32_32x32x16_bf16 v[48:63], v[136:139], a[108:111], v[48:63]
    ds_read_b64_tr_b16 v[134:135], v15 offset:64000
    v_mfma_f32_32x32x16_bf16 v[80:95], a[108:111], v[140:143], v[80:95]
    ds_read_b128 a[120:123], v9 offset:32768
    ds_read_b128 a[124:127], v9 offset:36864
    buffer_load_dwordx4 v24, s[12:15], s75 offen offset:3072 lds
    s_waitcnt lgkmcnt(6)
    v_mfma_f32_32x32x16_bf16 v[32:47], v[144:147], a[112:115], v[32:47]
    s_waitcnt vmcnt(8)
    s_barrier
    ds_read_b64_tr_b16 v[136:137], v14 offset:16384
    v_mfma_f32_32x32x16_bf16 v[64:79], a[112:115], v[148:151], v[64:79]
    ds_read_b64_tr_b16 v[138:139], v14 offset:16896
    ds_read_b64_tr_b16 v[140:141], v14 offset:24576
    s_add_u32 m0, s49, 65536
    s_nop 0
    buffer_load_dwordx4 v17, s[8:11], s76 offen lds
    v_mfma_f32_32x32x16_bf16 v[48:63], v[144:147], a[116:119], v[48:63]
    ds_read_b64_tr_b16 v[142:143], v14 offset:25088
    v_mfma_f32_32x32x16_bf16 v[80:95], a[116:119], v[148:151], v[80:95]
    ds_read_b128 a[128:131], v2 offset:0
    ds_read_b128 a[132:135], v2 offset:4096
    buffer_load_dwordx4 v18, s[8:11], s76 offen offset:1024 lds
    s_waitcnt lgkmcnt(6)
    v_mfma_f32_32x32x16_bf16 v[32:47], v[128:131], a[120:123], v[32:47]
    ds_read_b64_tr_b16 v[144:145], v14 offset:18432
    v_mfma_f32_32x32x16_bf16 v[64:79], a[120:123], v[132:135], v[64:79]
    ds_read_b64_tr_b16 v[146:147], v14 offset:18944
    ds_read_b64_tr_b16 v[148:149], v14 offset:26624
    buffer_load_dwordx4 v19, s[8:11], s76 offen offset:2048 lds
    v_mfma_f32_32x32x16_bf16 v[48:63], v[128:131], a[124:127], v[48:63]
    ds_read_b64_tr_b16 v[150:151], v14 offset:27136
    v_mfma_f32_32x32x16_bf16 v[80:95], a[124:127], v[132:135], v[80:95]
    ds_read_b128 a[136:139], v3 offset:0
    ds_read_b128 a[140:143], v3 offset:4096
    buffer_load_dwordx4 v20, s[8:11], s76 offen offset:3072 lds
    s_waitcnt lgkmcnt(6)
    v_mfma_f32_32x32x16_bf16 v[32:47], v[136:139], a[128:131], v[32:47]
    ds_read_b64_tr_b16 v[128:129], v14 offset:20480
    v_mfma_f32_32x32x16_bf16 v[64:79], a[128:131], v[140:143], v[64:79]
    ds_read_b64_tr_b16 v[130:131], v14 offset:20992
    ds_read_b64_tr_b16 v[132:133], v14 offset:28672
    s_add_u32 m0, s50, 65536
    s_nop 0
    buffer_load_dwordx4 v21, s[12:15], s77 offen lds
    v_mfma_f32_32x32x16_bf16 v[48:63], v[136:139], a[132:135], v[48:63]
    ds_read_b64_tr_b16 v[134:135], v14 offset:29184
    v_mfma_f32_32x32x16_bf16 v[80:95], a[132:135], v[140:143], v[80:95]
    ds_read_b128 a[144:147], v4 offset:0
    ds_read_b128 a[148:151], v4 offset:4096
    buffer_load_dwordx4 v22, s[12:15], s77 offen offset:1024 lds
    s_waitcnt lgkmcnt(6)
    v_mfma_f32_32x32x16_bf16 v[32:47], v[144:147], a[136:139], v[32:47]
    ds_read_b64_tr_b16 v[136:137], v14 offset:22528
    v_mfma_f32_32x32x16_bf16 v[64:79], a[136:139], v[148:151], v[64:79]
    ds_read_b64_tr_b16 v[138:139], v14 offset:23040
    ds_read_b64_tr_b16 v[140:141], v14 offset:30720
    buffer_load_dwordx4 v23, s[12:15], s77 offen offset:2048 lds
    v_mfma_f32_32x32x16_bf16 v[48:63], v[144:147], a[140:143], v[48:63]
    ds_read_b64_tr_b16 v[142:143], v14 offset:31232
    v_mfma_f32_32x32x16_bf16 v[80:95], a[140:143], v[148:151], v[80:95]
    ds_read_b128 a[152:155], v5 offset:0
    ds_read_b128 a[156:159], v5 offset:4096
    buffer_load_dwordx4 v24, s[12:15], s77 offen offset:3072 lds
    s_waitcnt lgkmcnt(6)
    v_mfma_f32_32x32x16_bf16 v[32:47], v[128:131], a[144:147], v[32:47]
    s_waitcnt vmcnt(8)
    s_barrier
    ds_read_b64_tr_b16 v[144:145], v14 offset:49152
    v_mfma_f32_32x32x16_bf16 v[64:79], a[144:147], v[132:135], v[64:79]
    ds_read_b64_tr_b16 v[146:147], v14 offset:49664
    ds_read_b64_tr_b16 v[148:149], v14 offset:57344
    s_add_u32 m0, s49, 98304
    s_nop 0
    buffer_load_dwordx4 v17, s[8:11], s78 offen lds
    v_mfma_f32_32x32x16_bf16 v[48:63], v[128:131], a[148:151], v[48:63]
    ds_read_b64_tr_b16 v[150:151], v14 offset:57856
    v_mfma_f32_32x32x16_bf16 v[80:95], a[148:151], v[132:135], v[80:95]
    ds_read_b128 a[160:163], v2 offset:32768
    ds_read_b128 a[164:167], v2 offset:36864
    buffer_load_dwordx4 v18, s[8:11], s78 offen offset:1024 lds
    s_waitcnt lgkmcnt(6)
    v_mfma_f32_32x32x16_bf16 v[32:47], v[136:139], a[152:155], v[32:47]
    ds_read_b64_tr_b16 v[128:129], v14 offset:51200
    v_mfma_f32_32x32x16_bf16 v[64:79], a[152:155], v[140:143], v[64:79]
    ds_read_b64_tr_b16 v[130:131], v14 offset:51712
    ds_read_b64_tr_b16 v[132:133], v14 offset:59392
    buffer_load_dwordx4 v19, s[8:11], s78 offen offset:2048 lds
    v_mfma_f32_32x32x16_bf16 v[48:63], v[136:139], a[156:159], v[48:63]
    ds_read_b64_tr_b16 v[134:135], v14 offset:59904
    v_mfma_f32_32x32x16_bf16 v[80:95], a[156:159], v[140:143], v[80:95]
    ds_read_b128 a[168:171], v3 offset:32768
    ds_read_b128 a[172:175], v3 offset:36864
    buffer_load_dwordx4 v20, s[8:11], s78 offen offset:3072 lds
    s_waitcnt lgkmcnt(6)
    v_mfma_f32_32x32x16_bf16 v[32:47], v[144:147], a[160:163], v[32:47]
    ds_read_b64_tr_b16 v[136:137], v14 offset:53248
    v_mfma_f32_32x32x16_bf16 v[64:79], a[160:163], v[148:151], v[64:79]
    ds_read_b64_tr_b16 v[138:139], v14 offset:53760
    ds_read_b64_tr_b16 v[140:141], v14 offset:61440
    s_add_u32 m0, s50, 98304
    s_nop 0
    buffer_load_dwordx4 v21, s[12:15], s79 offen lds
    v_mfma_f32_32x32x16_bf16 v[48:63], v[144:147], a[164:167], v[48:63]
    ds_read_b64_tr_b16 v[142:143], v14 offset:61952
    v_mfma_f32_32x32x16_bf16 v[80:95], a[164:167], v[148:151], v[80:95]
    ds_read_b128 a[176:179], v4 offset:32768
    ds_read_b128 a[180:183], v4 offset:36864
    buffer_load_dwordx4 v22, s[12:15], s79 offen offset:1024 lds
    s_waitcnt lgkmcnt(6)
    v_mfma_f32_32x32x16_bf16 v[32:47], v[128:131], a[168:171], v[32:47]
    ds_read_b64_tr_b16 v[144:145], v14 offset:55296
    v_mfma_f32_32x32x16_bf16 v[64:79], a[168:171], v[132:135], v[64:79]
    ds_read_b64_tr_b16 v[146:147], v14 offset:55808
    ds_read_b64_tr_b16 v[148:149], v14 offset:63488
    buffer_load_dwordx4 v23, s[12:15], s79 offen offset:2048 lds
    v_mfma_f32_32x32x16_bf16 v[48:63], v[128:131], a[172:175], v[48:63]
    ds_read_b64_tr_b16 v[150:151], v14 offset:64000
    v_mfma_f32_32x32x16_bf16 v[80:95], a[172:175], v[132:135], v[80:95]
    ds_read_b128 a[184:187], v5 offset:32768
    ds_read_b128 a[188:191], v5 offset:36864
    buffer_load_dwordx4 v24, s[12:15], s79 offen offset:3072 lds
    s_waitcnt lgkmcnt(6)
    v_mfma_f32_32x32x16_bf16 v[32:47], v[136:139], a[176:179], v[32:47]
    s_waitcnt vmcnt(8)
    s_barrier
    ds_read_b64_tr_b16 v[128:129], v15 offset:16384
    v_mfma_f32_32x32x16_bf16 v[64:79], a[176:179], v[140:143], v[64:79]
    ds_read_b64_tr_b16 v[130:131], v15 offset:16896
    ds_read_b64_tr_b16 v[132:133], v15 offset:24576
    s_add_u32 s52, s5, 0
    s_add_u32 m0, s61, 0
    s_nop 0
    buffer_load_dwordx4 v21, s[12:15], s52 offen lds
    v_mfma_f32_32x32x16_bf16 v[48:63], v[136:139], a[180:183], v[48:63]
    ds_read_b64_tr_b16 v[134:135], v15 offset:25088
    v_mfma_f32_32x32x16_bf16 v[80:95], a[180:183], v[140:143], v[80:95]
    ds_read_b128 a[192:195], v6 offset:0
    ds_read_b128 a[196:199], v6 offset:4096
    buffer_load_dwordx4 v22, s[12:15], s52 offen offset:1024 lds
    s_waitcnt lgkmcnt(6)
    v_mfma_f32_32x32x16_bf16 v[32:47], v[144:147], a[184:187], v[32:47]
    ds_read_b64_tr_b16 v[136:137], v15 offset:18432
    v_mfma_f32_32x32x16_bf16 v[64:79], a[184:187], v[148:151], v[64:79]
    ds_read_b64_tr_b16 v[138:139], v15 offset:18944
    ds_read_b64_tr_b16 v[140:141], v15 offset:26624
    s_sub_u32 s52, s67, s4
    s_add_u32 m0, s61, 8192
    s_nop 0
    buffer_load_dwordx4 v21, s[12:15], s52 offen lds
    v_mfma_f32_32x32x16_bf16 v[48:63], v[144:147], a[188:191], v[48:63]
    ds_read_b64_tr_b16 v[142:143], v15 offset:27136
    v_mfma_f32_32x32x16_bf16 v[80:95], a[188:191], v[148:151], v[80:95]
    ds_read_b128 a[200:203], v7 offset:0
    ds_read_b128 a[204:207], v7 offset:4096
    buffer_load_dwordx4 v22, s[12:15], s52 offen offset:1024 lds
    s_waitcnt lgkmcnt(6)
    v_mfma_f32_32x32x16_bf16 v[32:47], v[128:131], a[192:195], v[32:47]
    ds_read_b64_tr_b16 v[144:145], v15 offset:20480
    v_mfma_f32_32x32x16_bf16 v[64:79], a[192:195], v[132:135], v[64:79]
    ds_read_b64_tr_b16 v[146:147], v15 offset:20992
    ds_read_b64_tr_b16 v[148:149], v15 offset:28672
    s_sub_u32 s52, s69, s4
    s_add_u32 m0, s61, 16384
    s_nop 0
    buffer_load_dwordx4 v21, s[12:15], s52 offen lds
    v_mfma_f32_32x32x16_bf16 v[48:63], v[128:131], a[196:199], v[48:63]
    ds_read_b64_tr_b16 v[150:151], v15 offset:29184
    v_mfma_f32_32x32x16_bf16 v[80:95], a[196:199], v[132:135], v[80:95]
    ds_read_b128 a[208:211], v8 offset:0
    ds_read_b128 a[212:215], v8 offset:4096
    buffer_load_dwordx4 v22, s[12:15], s52 offen offset:1024 lds
    s_waitcnt lgkmcnt(6)
    v_mfma_f32_32x32x16_bf16 v[32:47], v[136:139], a[200:203], v[32:47]
    ds_read_b64_tr_b16 v[128:129], v15 offset:22528
    v_mfma_f32_32x32x16_bf16 v[64:79], a[200:203], v[140:143], v[64:79]
    ds_read_b64_tr_b16 v[130:131], v15 offset:23040
    ds_read_b64_tr_b16 v[132:133], v15 offset:30720
    s_sub_u32 s52, s71, s4
    s_add_u32 m0, s61, 24576
    s_nop 0
    buffer_load_dwordx4 v21, s[12:15], s52 offen lds
    v_mfma_f32_32x32x16_bf16 v[48:63], v[136:139], a[204:207], v[48:63]
    ds_read_b64_tr_b16 v[134:135], v15 offset:31232
    v_mfma_f32_32x32x16_bf16 v[80:95], a[204:207], v[140:143], v[80:95]
    ds_read_b128 a[216:219], v9 offset:0
    ds_read_b128 a[220:223], v9 offset:4096
    buffer_load_dwordx4 v22, s[12:15], s52 offen offset:1024 lds
    s_waitcnt lgkmcnt(6)
    v_mfma_f32_32x32x16_bf16 v[32:47], v[144:147], a[208:211], v[32:47]
    s_waitcnt vmcnt(8)
    s_barrier
    ds_read_b64_tr_b16 v[136:137], v15 offset:49152
    v_mfma_f32_32x32x16_bf16 v[64:79], a[208:211], v[148:151], v[64:79]
    ds_read_b64_tr_b16 v[138:139], v15 offset:49664
    ds_read_b64_tr_b16 v[140:141], v15 offset:57344
    s_sub_u32 s52, s73, s4
    s_add_u32 m0, s61, 131072
    s_nop 0
    buffer_load_dwordx4 v21, s[12:15], s52 offen lds
    v_mfma_f32_32x32x16_bf16 v[48:63], v[144:147], a[212:215], v[48:63]
    ds_read_b64_tr_b16 v[142:143], v15 offset:57856
    v_mfma_f32_32x32x16_bf16 v[80:95], a[212:215], v[148:151], v[80:95]
    ds_read_b128 a[224:227], v6 offset:32768
    ds_read_b128 a[228:231], v6 offset:36864
    buffer_load_dwordx4 v22, s[12:15], s52 offen offset:1024 lds
    s_waitcnt lgkmcnt(6)
    v_mfma_f32_32x32x16_bf16 v[32:47], v[128:131], a[216:219], v[32:47]
    ds_read_b64_tr_b16 v[144:145], v15 offset:51200
    v_mfma_f32_32x32x16_bf16 v[64:79], a[216:219], v[132:135], v[64:79]
    ds_read_b64_tr_b16 v[146:147], v15 offset:51712
    ds_read_b64_tr_b16 v[148:149], v15 offset:59392
    s_sub_u32 s52, s75, s4
    s_add_u32 m0, s61, 139264
    s_nop 0
    buffer_load_dwordx4 v21, s[12:15], s52 offen lds
    v_mfma_f32_32x32x16_bf16 v[48:63], v[128:131], a[220:223], v[48:63]
    ds_read_b64_tr_b16 v[150:151], v15 offset:59904
    v_mfma_f32_32x32x16_bf16 v[80:95], a[220:223], v[132:135], v[80:95]
    ds_read_b128 a[232:235], v7 offset:32768
    ds_read_b128 a[236:239], v7 offset:36864
    buffer_load_dwordx4 v22, s[12:15], s52 offen offset:1024 lds
    s_waitcnt lgkmcnt(6)
    v_mfma_f32_32x32x16_bf16 v[32:47], v[136:139], a[224:227], v[32:47]
    ds_read_b64_tr_b16 v[128:129], v15 offset:53248
    v_mfma_f32_32x32x16_bf16 v[64:79], a[224:227], v[140:143], v[64:79]
    ds_read_b64_tr_b16 v[130:131], v15 offset:53760
    ds_read_b64_tr_b16 v[132:133], v15 offset:61440
    s_sub_u32 s52, s77, s4
    s_add_u32 m0, s61, 147456
    s_nop 0
    buffer_load_dwordx4 v21, s[12:15], s52 offen lds
    v_mfma_f32_32x32x16_bf16 v[48:63], v[136:139], a[228:231], v[48:63]
    ds_read_b64_tr_b16 v[134:135], v15 offset:61952
    v_mfma_f32_32x32x16_bf16 v[80:95], a[228:231], v[140:143], v[80:95]
    ds_read_b128 a[240:243], v8 offset:32768
    ds_read_b128 a[244:247], v8 offset:36864
    buffer_load_dwordx4 v22, s[12:15], s52 offen offset:1024 lds
    s_waitcnt lgkmcnt(6)
    v_mfma_f32_32x32x16_bf16 v[32:47], v[144:147], a[232:235], v[32:47]
    ds_read_b64_tr_b16 v[136:137], v15 offset:55296
    v_mfma_f32_32x32x16_bf16 v[64:79], a[232:235], v[148:151], v[64:79]
    ds_read_b64_tr_b16 v[138:139], v15 offset:55808
    ds_read_b64_tr_b16 v[140:141], v15 offset:63488
    s_sub_u32 s52, s79, s4
    s_add_u32 m0, s61, 155648
    s_nop 0
    buffer_load_dwordx4 v21, s[12:15], s52 offen lds
    v_mfma_f32_32x32x16_bf16 v[48:63], v[144:147], a[236:239], v[48:63]
    ds_read_b64_tr_b16 v[142:143], v15 offset:64000
    v_mfma_f32_32x32x16_bf16 v[80:95], a[236:239], v[148:151], v[80:95]
    ds_read_b128 a[248:251], v9 offset:32768
    ds_read_b128 a[252:255], v9 offset:36864
    buffer_load_dwordx4 v22, s[12:15], s52 offen offset:1024 lds
    s_waitcnt lgkmcnt(6)
    v_mfma_f32_32x32x16_bf16 v[32:47], v[128:131], a[240:243], v[32:47]
    v_mfma_f32_32x32x16_bf16 v[64:79], a[240:243], v[132:135], v[64:79]
    v_mfma_f32_32x32x16_bf16 v[48:63], v[128:131], a[244:247], v[48:63]
    v_mfma_f32_32x32x16_bf16 v[80:95], a[244:247], v[132:135], v[80:95]
    s_waitcnt lgkmcnt(0)
    v_mfma_f32_32x32x16_bf16 v[32:47], v[136:139], a[248:251], v[32:47]
    v_mfma_f32_32x32x16_bf16 v[64:79], a[248:251], v[140:143], v[64:79]
    v_mfma_f32_32x32x16_bf16 v[48:63], v[136:139], a[252:255], v[48:63]
    v_mfma_f32_32x32x16_bf16 v[80:95], a[252:255], v[140:143], v[80:95]
    s_barrier
    v_readfirstlane_b32 s46, v26
    s_nop 0
    s_mul_i32 s46, s46, 0x9e3779b1
    s_add_u32 s46, s46, 0x7f4a7c15
    v_mov_b32 v26, s46
    s_nop 2
    v_cvt_pk_bf16_f32 v168, v40, v41
    v_cvt_pk_bf16_f32 v169, v42, v43
    v_cvt_pk_bf16_f32 v170, v44, v45
    v_cvt_pk_bf16_f32 v171, v46, v47
    v_cvt_pk_bf16_f32 v172, v56, v57
    v_cvt_pk_bf16_f32 v173, v58, v59
    v_mfma_f32_32x32x16_bf16 v[184:199], v[156:159], v[168:171], 0
    v_cvt_pk_bf16_f32 v174, v60, v61
    v_cvt_pk_bf16_f32 v175, v62, v63
    v_cvt_pk_bf16_f32 v176, v32, v33
    v_cvt_pk_bf16_f32 v177, v34, v35
    v_mfma_f32_32x32x16_bf16 v[200:215], v[156:159], v[172:175], 0
    v_cvt_pk_bf16_f32 v178, v36, v37
    v_cvt_pk_bf16_f32 v179, v38, v39
    v_cvt_pk_bf16_f32 v180, v48, v49
    v_cvt_pk_bf16_f32 v181, v50, v51
    v_mfma_f32_32x32x16_bf16 v[216:231], v[152:155], v[176:179], 0
    v_cvt_pk_bf16_f32 v182, v52, v53
    s_mov_b32 s52, s96
    s_add_u32 m0, s97, 32768
    s_nop 0
    buffer_load_dwordx4 v10, s[16:19], s52 offen lds
    v_cvt_pk_bf16_f32 v183, v54, v55
    v_cvt_pk_bf16_f32 v32, v64, v65
    v_cvt_pk_bf16_f32 v33, v66, v67
    v_cvt_pk_bf16_f32 v34, v68, v69
    v_cvt_pk_bf16_f32 v35, v70, v71
    v_mfma_f32_32x32x16_bf16 v[232:247], v[152:155], v[180:183], 0
    v_cvt_pk_bf16_f32 v36, v72, v73
    v_cvt_pk_bf16_f32 v37, v74, v75
    v_cvt_pk_bf16_f32 v38, v76, v77
    v_cvt_pk_bf16_f32 v39, v78, v79
    v_cvt_pk_bf16_f32 v40, v80, v81
    v_cvt_pk_bf16_f32 v41, v82, v83
    v_cvt_pk_bf16_f32 v42, v84, v85
    v_cvt_pk_bf16_f32 v43, v86, v87
    buffer_load_dwordx4 v11, s[16:19], s52 offen offset:1024 lds
    v_cvt_pk_bf16_f32 v44, v88, v89
    v_cvt_pk_bf16_f32 v45, v90, v91
    v_cvt_pk_bf16_f32 v46, v92, v93
    v_cvt_pk_bf16_f32 v47, v94, v95
    v_cndmask_b32_e64 v48, v25, v32, s[62:63]
    v_cndmask_b32_e64 v49, v25, v33, s[62:63]
    v_cndmask_b32_e64 v50, v25, v34, s[62:63]
    v_cndmask_b32_e64 v51, v25, v35, s[62:63]
    v_cndmask_b32_e64 v52, v25, v36, s[62:63]
    v_cndmask_b32_e64 v53, v25, v37, s[62:63]
    v_cndmask_b32_e64 v54, v25, v38, s[62:63]
    v_cndmask_b32_e64 v55, v25, v39, s[62:63]
    v_cndmask_b32_e64 v56, v25, v40, s[62:63]
    v_cndmask_b32_e64 v57, v25, v41, s[62:63]
    buffer_load_dwordx4 v12, s[16:19], s52 offen offset:2048 lds
    v_cndmask_b32_e64 v58, v25, v42, s[62:63]
    v_cndmask_b32_e64 v59, v25, v43, s[62:63]
    v_cndmask_b32_e64 v60, v25, v44, s[62:63]
    v_cndmask_b32_e64 v61, v25, v45, s[62:63]
    v_cndmask_b32_e64 v62, v25, v46, s[62:63]
    v_cndmask_b32_e64 v63, v25, v47, s[62:63]
    v_cndmask_b32_e64 v32, v32, v25, s[62:63]
    v_cndmask_b32_e64 v33, v33, v25, s[62:63]
    v_cndmask_b32_e64 v34, v34, v25, s[62:63]
    v_cndmask_b32_e64 v35, v35, v25, s[62:63]
    v_cndmask_b32_e64 v36, v36, v25, s[62:63]
    v_cndmask_b32_e64 v37, v37, v25, s[62:63]
    v_cndmask_b32_e64 v38, v38, v25, s[62:63]
    v_cndmask_b32_e64 v39, v39, v25, s[62:63]
    buffer_load_dwordx4 v13, s[16:19], s52 offen offset:3072 lds
    v_cndmask_b32_e64 v40, v40, v25, s[62:63]
    v_cndmask_b32_e64 v41, v41, v25, s[62:63]
    v_cndmask_b32_e64 v42, v42, v25, s[62:63]
    v_cndmask_b32_e64 v43, v43, v25, s[62:63]
    v_cndmask_b32_e64 v44, v44, v25, s[62:63]
    v_cndmask_b32_e64 v45, v45, v25, s[62:63]
    v_cndmask_b32_e64 v46, v46, v25, s[62:63]
    v_cndmask_b32_e64 v47, v47, v25, s[62:63]
    v_max3_f32 v136, v184, v185, v186
    v_max3_f32 v137, v187, v188, v189
    v_max3_f32 v136, v136, v190, v191
    v_max3_f32 v137, v137, v192, v193
    v_max3_f32 v136, v136, v194, v195
    v_max3_f32 v137, v137, v196, v197
    s_mov_b32 s52, s96
    s_add_u32 s52, s52, 32768
    s_add_u32 m0, s97, 36864
    s_nop 0
    buffer_load_dwordx4 v10, s[16:19], s52 offen lds
    v_max3_f32 v136, v136, v198, v199
    v_max_f32 v136, v136, v137
    v_mul_f32 v136, s84, v136
    v_pk_fma_f32 v[184:185], v[184:185], s[84:85], v[136:137] op_sel_hi:[1,1,0] neg_lo:[0,0,1] neg_hi:[0,0,1]
    v_pk_fma_f32 v[186:187], v[186:187], s[84:85], v[136:137] op_sel_hi:[1,1,0] neg_lo:[0,0,1] neg_hi:[0,0,1]
    v_pk_fma_f32 v[188:189], v[188:189], s[84:85], v[136:137] op_sel_hi:[1,1,0] neg_lo:[0,0,1] neg_hi:[0,0,1]
    v_pk_fma_f32 v[190:191], v[190:191], s[84:85], v[136:137] op_sel_hi:[1,1,0] neg_lo:[0,0,1] neg_hi:[0,0,1]
    v_pk_fma_f32 v[192:193], v[192:193], s[84:85], v[136:137] op_sel_hi:[1,1,0] neg_lo:[0,0,1] neg_hi:[0,0,1]
    v_pk_fma_f32 v[194:195], v[194:195], s[84:85], v[136:137] op_sel_hi:[1,1,0] neg_lo:[0,0,1] neg_hi:[0,0,1]
    v_pk_fma_f32 v[196:197], v[196:197], s[84:85], v[136:137] op_sel_hi:[1,1,0] neg_lo:[0,0,1] neg_hi:[0,0,1]
    v_pk_fma_f32 v[198:199], v[198:199], s[84:85], v[136:137] op_sel_hi:[1,1,0] neg_lo:[0,0,1] neg_hi:[0,0,1]
    v_exp_f32 v184, v184
    v_exp_f32 v185, v185
    v_exp_f32 v186, v186
    buffer_load_dwordx4 v11, s[16:19], s52 offen offset:1024 lds
    v_exp_f32 v187, v187
    v_exp_f32 v188, v188
    v_exp_f32 v189, v189
    v_exp_f32 v190, v190
    v_exp_f32 v191, v191
    v_exp_f32 v192, v192
    v_exp_f32 v193, v193
    v_exp_f32 v194, v194
    v_exp_f32 v195, v195
    v_exp_f32 v196, v196
    v_exp_f32 v197, v197
    v_exp_f32 v198, v198
    v_exp_f32 v199, v199
    v_pk_add_f32 v[138:139], v[184:185], v[186:187]
    buffer_load_dwordx4 v12, s[16:19], s52 offen offset:2048 lds
    v_pk_add_f32 v[136:137], v[188:189], v[190:191]
    v_pk_add_f32 v[138:139], v[138:139], v[192:193]
    v_pk_add_f32 v[136:137], v[136:137], v[194:195]
    v_pk_add_f32 v[138:139], v[138:139], v[196:197]
    v_pk_add_f32 v[136:137], v[136:137], v[198:199]
    v_pk_add_f32 v[138:139], v[138:139], v[136:137]
    v_add_f32 v138, v138, v139
    v_rcp_f32 v138, v138
    s_nop 0
    v_pk_mul_f32 v[184:185], v[184:185], v[138:139] op_sel_hi:[1,0]
    v_pk_mul_f32 v[186:187], v[186:187], v[138:139] op_sel_hi:[1,0]
    v_pk_mul_f32 v[188:189], v[188:189], v[138:139] op_sel_hi:[1,0]
    v_pk_mul_f32 v[190:191], v[190:191], v[138:139] op_sel_hi:[1,0]
    v_pk_mul_f32 v[192:193], v[192:193], v[138:139] op_sel_hi:[1,0]
    v_pk_mul_f32 v[194:195], v[194:195], v[138:139] op_sel_hi:[1,0]
    buffer_load_dwordx4 v13, s[16:19], s52 offen offset:3072 lds
    v_pk_mul_f32 v[196:197], v[196:197], v[138:139] op_sel_hi:[1,0]
    v_pk_mul_f32 v[198:199], v[198:199], v[138:139] op_sel_hi:[1,0]
    v_cvt_pk_bf16_f32 v168, v184, v185
    v_cvt_pk_bf16_f32 v169, v186, v187
    v_cvt_pk_bf16_f32 v170, v188, v189
    v_cvt_pk_bf16_f32 v171, v190, v191
    v_cvt_pk_bf16_f32 v172, v192, v193
    v_cvt_pk_bf16_f32 v173, v194, v195
    v_cvt_pk_bf16_f32 v174, v196, v197
    v_cvt_pk_bf16_f32 v175, v198, v199
    v_max3_f32 v136, v200, v201, v202
    v_max3_f32 v137, v203, v204, v205
    v_max3_f32 v136, v136, v206, v207
    v_max3_f32 v137, v137, v208, v209
    v_max3_f32 v136, v136, v210, v211
    v_max3_f32 v137, v137, v212, v213
    v_max3_f32 v136, v136, v214, v215
    v_max_f32 v136, v136, v137
    v_mul_f32 v136, s84, v136
    v_pk_fma_f32 v[200:201], v[200:201], s[84:85], v[136:137] op_sel_hi:[1,1,0] neg_lo:[0,0,1] neg_hi:[0,0,1]
    v_pk_fma_f32 v[202:203], v[202:203], s[84:85], v[136:137] op_sel_hi:[1,1,0] neg_lo:[0,0,1] neg_hi:[0,0,1]
    v_pk_fma_f32 v[204:205], v[204:205], s[84:85], v[136:137] op_sel_hi:[1,1,0] neg_lo:[0,0,1] neg_hi:[0,0,1]
    v_pk_fma_f32 v[206:207], v[206:207], s[84:85], v[136:137] op_sel_hi:[1,1,0] neg_lo:[0,0,1] neg_hi:[0,0,1]
    v_pk_fma_f32 v[208:209], v[208:209], s[84:85], v[136:137] op_sel_hi:[1,1,0] neg_lo:[0,0,1] neg_hi:[0,0,1]
    v_pk_fma_f32 v[210:211], v[210:211], s[84:85], v[136:137] op_sel_hi:[1,1,0] neg_lo:[0,0,1] neg_hi:[0,0,1]
    v_pk_fma_f32 v[212:213], v[212:213], s[84:85], v[136:137] op_sel_hi:[1,1,0] neg_lo:[0,0,1] neg_hi:[0,0,1]
    v_pk_fma_f32 v[214:215], v[214:215], s[84:85], v[136:137] op_sel_hi:[1,1,0] neg_lo:[0,0,1] neg_hi:[0,0,1]
    v_mfma_f32_32x32x16_bf16 v[64:79], v[168:171], v[160:163], 0
    v_exp_f32 v200, v200
    v_exp_f32 v201, v201
    v_exp_f32 v202, v202
    v_exp_f32 v203, v203
    v_mfma_f32_32x32x16_bf16 v[64:79], v[172:175], v[164:167], v[64:79]
    v_exp_f32 v204, v204
    v_exp_f32 v205, v205
    v_exp_f32 v206, v206
    v_exp_f32 v207, v207
    v_exp_f32 v208, v208
    v_exp_f32 v209, v209
    v_exp_f32 v210, v210
    v_exp_f32 v211, v211
    v_exp_f32 v212, v212
    v_exp_f32 v213, v213
    v_exp_f32 v214, v214
    v_exp_f32 v215, v215
    v_pk_add_f32 v[138:139], v[200:201], v[202:203]
    v_pk_add_f32 v[136:137], v[204:205], v[206:207]
    v_cvt_pk_bf16_f32 v128, v64, v65
    v_pk_add_f32 v[138:139], v[138:139], v[208:209]
    v_cvt_pk_bf16_f32 v129, v66, v67
    v_pk_add_f32 v[136:137], v[136:137], v[210:211]
    v_cvt_pk_bf16_f32 v130, v68, v69
    v_pk_add_f32 v[138:139], v[138:139], v[212:213]
    v_cvt_pk_bf16_f32 v131, v70, v71
    v_pk_add_f32 v[136:137], v[136:137], v[214:215]
    v_cvt_pk_bf16_f32 v132, v72, v73
    v_pk_add_f32 v[138:139], v[138:139], v[136:137]
    v_cvt_pk_bf16_f32 v133, v74, v75
    v_add_f32 v138, v138, v139
    v_cvt_pk_bf16_f32 v134, v76, v77
    v_rcp_f32 v138, v138
    v_cvt_pk_bf16_f32 v135, v78, v79
    v_pk_mul_f32 v[200:201], v[200:201], v[138:139] op_sel_hi:[1,0]
    v_pk_mul_f32 v[202:203], v[202:203], v[138:139] op_sel_hi:[1,0]
    v_pk_mul_f32 v[204:205], v[204:205], v[138:139] op_sel_hi:[1,0]
    v_pk_mul_f32 v[206:207], v[206:207], v[138:139] op_sel_hi:[1,0]
    v_pk_mul_f32 v[208:209], v[208:209], v[138:139] op_sel_hi:[1,0]
    v_pk_mul_f32 v[210:211], v[210:211], v[138:139] op_sel_hi:[1,0]
    v_pk_mul_f32 v[212:213], v[212:213], v[138:139] op_sel_hi:[1,0]
    v_pk_mul_f32 v[214:215], v[214:215], v[138:139] op_sel_hi:[1,0]
    v_cvt_pk_bf16_f32 v176, v200, v201
    v_cvt_pk_bf16_f32 v177, v202, v203
    v_cvt_pk_bf16_f32 v178, v204, v205
    v_cvt_pk_bf16_f32 v179, v206, v207
    v_cvt_pk_bf16_f32 v180, v208, v209
    v_cvt_pk_bf16_f32 v181, v210, v211
    v_cvt_pk_bf16_f32 v182, v212, v213
    v_cvt_pk_bf16_f32 v183, v214, v215
    v_max3_f32 v136, v216, v217, v218
    v_max3_f32 v137, v219, v220, v221
    v_max3_f32 v136, v136, v222, v223
    v_max3_f32 v137, v137, v224, v225
    v_max3_f32 v136, v136, v226, v227
    v_max3_f32 v137, v137, v228, v229
    v_max3_f32 v136, v136, v230, v231
    v_max_f32 v136, v136, v137
    v_mul_f32 v136, s84, v136
    v_pk_fma_f32 v[216:217], v[216:217], s[84:85], v[136:137] op_sel_hi:[1,1,0] neg_lo:[0,0,1] neg_hi:[0,0,1]
    v_pk_fma_f32 v[218:219], v[218:219], s[84:85], v[136:137] op_sel_hi:[1,1,0] neg_lo:[0,0,1] neg_hi:[0,0,1]
    v_pk_fma_f32 v[220:221], v[220:221], s[84:85], v[136:137] op_sel_hi:[1,1,0] neg_lo:[0,0,1] neg_hi:[0,0,1]
    v_lshlrev_b32 v27, 4, v1
    v_pk_fma_f32 v[222:223], v[222:223], s[84:85], v[136:137] op_sel_hi:[1,1,0] neg_lo:[0,0,1] neg_hi:[0,0,1]
    s_lshl_b32 s53, s40, 12
    v_pk_fma_f32 v[224:225], v[224:225], s[84:85], v[136:137] op_sel_hi:[1,1,0] neg_lo:[0,0,1] neg_hi:[0,0,1]
    s_add_u32 s53, s53, 98304
    v_pk_fma_f32 v[226:227], v[226:227], s[84:85], v[136:137] op_sel_hi:[1,1,0] neg_lo:[0,0,1] neg_hi:[0,0,1]
    v_add_u32 v28, s53, v27
    v_pk_fma_f32 v[228:229], v[228:229], s[84:85], v[136:137] op_sel_hi:[1,1,0] neg_lo:[0,0,1] neg_hi:[0,0,1]
    s_xor_b32 s53, s53, 4096
    v_pk_fma_f32 v[230:231], v[230:231], s[84:85], v[136:137] op_sel_hi:[1,1,0] neg_lo:[0,0,1] neg_hi:[0,0,1]
    v_mfma_f32_32x32x16_bf16 v[80:95], v[176:179], v[160:163], 0
    v_xor_b32 v27, 256, v27
    v_exp_f32 v216, v216
    v_add_u32 v29, s53, v27
    v_exp_f32 v217, v217
    v_lshrrev_b32 v30, 4, v1
    v_exp_f32 v218, v218
    v_lshlrev_b32 v30, 12, v30
    v_exp_f32 v219, v219
    v_mfma_f32_32x32x16_bf16 v[80:95], v[180:183], v[164:167], v[80:95]
    v_and_b32 v27, 15, v1
    v_exp_f32 v220, v220
    v_lshl_add_u32 v30, v27, 4, v30
    v_exp_f32 v221, v221
    v_exp_f32 v222, v222
    v_exp_f32 v223, v223
    v_mfma_f32_32x32x16_bf16 v[112:127], v[128:131], v[48:51], 0
    v_exp_f32 v224, v224
    v_exp_f32 v225, v225
    v_exp_f32 v226, v226
    v_exp_f32 v227, v227
    v_mfma_f32_32x32x16_bf16 v[112:127], v[132:135], v[52:55], v[112:127]
    v_exp_f32 v228, v228
    v_exp_f32 v229, v229
    v_exp_f32 v230, v230
    v_exp_f32 v231, v231
    v_pk_add_f32 v[138:139], v[216:217], v[218:219]
    v_pk_add_f32 v[136:137], v[220:221], v[222:223]
    v_cvt_pk_bf16_f32 v128, v80, v81
    v_pk_add_f32 v[138:139], v[138:139], v[224:225]
    v_cvt_pk_bf16_f32 v129, v82, v83
    v_pk_add_f32 v[136:137], v[136:137], v[226:227]
    v_cvt_pk_bf16_f32 v130, v84, v85
    v_pk_add_f32 v[138:139], v[138:139], v[228:229]
    v_cvt_pk_bf16_f32 v131, v86, v87
    v_pk_add_f32 v[136:137], v[136:137], v[230:231]
    v_cvt_pk_bf16_f32 v132, v88, v89
    v_pk_add_f32 v[138:139], v[138:139], v[136:137]
    v_cvt_pk_bf16_f32 v133, v90, v91
    v_add_f32 v138, v138, v139
    v_cvt_pk_bf16_f32 v134, v92, v93
    v_rcp_f32 v138, v138
    v_cvt_pk_bf16_f32 v135, v94, v95
    v_pk_mul_f32 v[216:217], v[216:217], v[138:139] op_sel_hi:[1,0]
    v_pk_mul_f32 v[218:219], v[218:219], v[138:139] op_sel_hi:[1,0]
    v_pk_mul_f32 v[220:221], v[220:221], v[138:139] op_sel_hi:[1,0]
    v_pk_mul_f32 v[222:223], v[222:223], v[138:139] op_sel_hi:[1,0]
    v_pk_mul_f32 v[224:225], v[224:225], v[138:139] op_sel_hi:[1,0]
    v_pk_mul_f32 v[226:227], v[226:227], v[138:139] op_sel_hi:[1,0]
    v_pk_mul_f32 v[228:229], v[228:229], v[138:139] op_sel_hi:[1,0]
    v_pk_mul_f32 v[230:231], v[230:231], v[138:139] op_sel_hi:[1,0]
    v_cvt_pk_bf16_f32 v168, v216, v217
    v_cvt_pk_bf16_f32 v169, v218, v219
    v_cvt_pk_bf16_f32 v170, v220, v221
    v_cvt_pk_bf16_f32 v171, v222, v223
    v_cvt_pk_bf16_f32 v172, v224, v225
    v_cvt_pk_bf16_f32 v173, v226, v227
    v_cvt_pk_bf16_f32 v174, v228, v229
    v_cvt_pk_bf16_f32 v175, v230, v231
    v_max3_f32 v136, v232, v233, v234
    v_max3_f32 v137, v235, v236, v237
    v_max3_f32 v136, v136, v238, v239
    v_max3_f32 v137, v137, v240, v241
    s_lshl_b32 s59, s44, 2
    v_max3_f32 v136, v136, v242, v243
    s_add_u32 s59, s59, s40
    v_max3_f32 v137, v137, v244, v245
    s_add_u32 s59, s59, 32
    v_max3_f32 v136, v136, v246, v247
    s_lshl_b32 s55, s59, 16
    v_max_f32 v136, v136, v137
    s_lshl_b32 s54, s43, 8
    v_mul_f32 v136, s84, v136
    s_add_u32 s55, s55, s54
    v_pk_fma_f32 v[232:233], v[232:233], s[84:85], v[136:137] op_sel_hi:[1,1,0] neg_lo:[0,0,1] neg_hi:[0,0,1]
    s_add_u32 s55, s55, 8388608
    v_pk_fma_f32 v[234:235], v[234:235], s[84:85], v[136:137] op_sel_hi:[1,1,0] neg_lo:[0,0,1] neg_hi:[0,0,1]
    v_pk_fma_f32 v[236:237], v[236:237], s[84:85], v[136:137] op_sel_hi:[1,1,0] neg_lo:[0,0,1] neg_hi:[0,0,1]
    v_pk_fma_f32 v[238:239], v[238:239], s[84:85], v[136:137] op_sel_hi:[1,1,0] neg_lo:[0,0,1] neg_hi:[0,0,1]
    v_pk_fma_f32 v[240:241], v[240:241], s[84:85], v[136:137] op_sel_hi:[1,1,0] neg_lo:[0,0,1] neg_hi:[0,0,1]
    v_pk_fma_f32 v[242:243], v[242:243], s[84:85], v[136:137] op_sel_hi:[1,1,0] neg_lo:[0,0,1] neg_hi:[0,0,1]
    v_pk_fma_f32 v[244:245], v[244:245], s[84:85], v[136:137] op_sel_hi:[1,1,0] neg_lo:[0,0,1] neg_hi:[0,0,1]
    v_pk_fma_f32 v[246:247], v[246:247], s[84:85], v[136:137] op_sel_hi:[1,1,0] neg_lo:[0,0,1] neg_hi:[0,0,1]
    v_mfma_f32_32x32x16_bf16 v[64:79], v[168:171], v[160:163], 0
    v_exp_f32 v232, v232
    v_exp_f32 v233, v233
    v_exp_f32 v234, v234
    v_exp_f32 v235, v235
    v_mfma_f32_32x32x16_bf16 v[64:79], v[172:175], v[164:167], v[64:79]
    v_exp_f32 v236, v236
    v_exp_f32 v237, v237
    v_exp_f32 v238, v238
    v_exp_f32 v239, v239
    v_mfma_f32_32x32x16_bf16 v[112:127], v[128:131], v[56:59], v[112:127]
    v_exp_f32 v240, v240
    v_exp_f32 v241, v241
    v_exp_f32 v242, v242
    v_exp_f32 v243, v243
    v_mfma_f32_32x32x16_bf16 v[112:127], v[132:135], v[60:63], v[112:127]
    v_exp_f32 v244, v244
    v_exp_f32 v245, v245
    v_exp_f32 v246, v246
    v_exp_f32 v247, v247
    v_pk_add_f32 v[138:139], v[232:233], v[234:235]
    v_pk_add_f32 v[136:137], v[236:237], v[238:239]
    v_cvt_pk_bf16_f32 v128, v64, v65
    v_pk_add_f32 v[138:139], v[138:139], v[240:241]
    v_cvt_pk_bf16_f32 v129, v66, v67
    v_pk_add_f32 v[136:137], v[136:137], v[242:243]
    v_cvt_pk_bf16_f32 v130, v68, v69
    v_pk_add_f32 v[138:139], v[138:139], v[244:245]
    v_cvt_pk_bf16_f32 v131, v70, v71
    v_pk_add_f32 v[136:137], v[136:137], v[246:247]
    v_cvt_pk_bf16_f32 v132, v72, v73
    v_pk_add_f32 v[138:139], v[138:139], v[136:137]
    v_cvt_pk_bf16_f32 v133, v74, v75
    v_add_f32 v138, v138, v139
    v_cvt_pk_bf16_f32 v134, v76, v77
    v_rcp_f32 v138, v138
    v_cvt_pk_bf16_f32 v135, v78, v79
    v_pk_mul_f32 v[232:233], v[232:233], v[138:139] op_sel_hi:[1,0]
    v_pk_mul_f32 v[234:235], v[234:235], v[138:139] op_sel_hi:[1,0]
    v_pk_mul_f32 v[236:237], v[236:237], v[138:139] op_sel_hi:[1,0]
    v_pk_mul_f32 v[238:239], v[238:239], v[138:139] op_sel_hi:[1,0]
    ds_write_b128 v28, v[112:115] offset:0
    v_pk_mul_f32 v[240:241], v[240:241], v[138:139] op_sel_hi:[1,0]
    v_pk_mul_f32 v[242:243], v[242:243], v[138:139] op_sel_hi:[1,0]
    ds_write_b128 v28, v[116:119] offset:1024
    v_pk_mul_f32 v[244:245], v[244:245], v[138:139] op_sel_hi:[1,0]
    v_pk_mul_f32 v[246:247], v[246:247], v[138:139] op_sel_hi:[1,0]
    ds_write_b128 v28, v[120:123] offset:2048
    v_cvt_pk_bf16_f32 v176, v232, v233
    v_cvt_pk_bf16_f32 v177, v234, v235
    ds_write_b128 v28, v[124:127] offset:3072
    v_cvt_pk_bf16_f32 v178, v236, v237
    v_cvt_pk_bf16_f32 v179, v238, v239
    v_cvt_pk_bf16_f32 v180, v240, v241
    v_cvt_pk_bf16_f32 v181, v242, v243
    v_cvt_pk_bf16_f32 v182, v244, v245
    v_cvt_pk_bf16_f32 v183, v246, v247
    s_nop 1
    v_mfma_f32_32x32x16_bf16 v[80:95], v[176:179], v[160:163], 0
    v_mov_b32 v187, v26
    v_mov_b32 v191, v26
    v_mov_b32 v195, v26
    v_mov_b32 v199, v26
    v_mfma_f32_32x32x16_bf16 v[80:95], v[180:183], v[164:167], v[80:95]
    v_mfma_f32_32x32x16_bf16 v[96:111], v[128:131], v[32:35], 0
    v_mfma_f32_32x32x16_bf16 v[96:111], v[132:135], v[36:39], v[96:111]
    s_waitcnt vmcnt(8) lgkmcnt(0)
    s_barrier
    ds_read_b128 v[216:219], v29 offset:0
    ds_read_b128 v[220:223], v29 offset:1024
    ds_read_b128 v[224:227], v29 offset:2048
    ds_read_b128 v[228:231], v29 offset:3072
    s_nop 3
    v_cvt_pk_bf16_f32 v128, v80, v81
    v_cvt_pk_bf16_f32 v129, v82, v83
    v_cvt_pk_bf16_f32 v130, v84, v85
    v_cvt_pk_bf16_f32 v131, v86, v87
    v_cvt_pk_bf16_f32 v132, v88, v89
    v_cvt_pk_bf16_f32 v133, v90, v91
    v_cvt_pk_bf16_f32 v134, v92, v93
    v_cvt_pk_bf16_f32 v135, v94, v95
    s_nop 1
    v_mfma_f32_32x32x16_bf16 v[96:111], v[128:131], v[40:43], v[96:111]
    v_mfma_f32_32x32x16_bf16 v[96:111], v[132:135], v[44:47], v[96:111]
    s_waitcnt lgkmcnt(0)
    s_nop 10
    v_add_f32 v184, v96, v216
    v_add_f32 v185, v97, v217
    v_add_f32 v188, v98, v218
    v_add_f32 v189, v99, v219
    v_add_f32 v192, v100, v220
    v_add_f32 v193, v101, v221
    v_add_f32 v196, v102, v222
    v_add_f32 v197, v103, v223
    v_add_f32 v200, v104, v224
    v_add_f32 v201, v105, v225
    v_add_f32 v202, v106, v226
    v_add_f32 v203, v107, v227
    v_add_f32 v204, v108, v228
    v_add_f32 v205, v109, v229
    v_add_f32 v206, v110, v230
    v_add_f32 v207, v111, v231
    v_permlane16_swap_b32 v184, v200
    v_permlane16_swap_b32 v185, v201
    v_permlane16_swap_b32 v188, v202
    v_permlane16_swap_b32 v189, v203
    v_permlane16_swap_b32 v192, v204
    v_permlane16_swap_b32 v193, v205
    v_permlane16_swap_b32 v196, v206
    v_permlane16_swap_b32 v197, v207
    v_cndmask_b32_e64 v186, v200, v201, s[94:95]
    v_cndmask_b32_e64 v190, v202, v203, s[94:95]
    v_cndmask_b32_e64 v194, v204, v205, s[94:95]
    v_cndmask_b32_e64 v198, v206, v207, s[94:95]
    ds_read_b64_tr_b16 v[128:129], v14 offset:0
    ds_read_b64_tr_b16 v[130:131], v14 offset:512
    ds_read_b64_tr_b16 v[132:133], v14 offset:2048
    ds_read_b64_tr_b16 v[134:135], v14 offset:2560
    ds_read_b64_tr_b16 v[136:137], v14 offset:4096
    ds_read_b64_tr_b16 v[138:139], v14 offset:4608
    s_waitcnt lgkmcnt(4)
    v_mfma_f32_32x32x16_bf16 v[96:111], v[128:131], a[0:3], 0
    ds_read_b64_tr_b16 v[140:141], v14 offset:6144
    ds_read_b64_tr_b16 v[142:143], v14 offset:6656
    buffer_store_dwordx4 v[184:187], v30, s[24:27], s55 offen sc1
    s_add_u32 s55, s55, 16384
    v_mfma_f32_32x32x16_bf16 v[112:127], v[128:131], a[4:7], 0
    s_waitcnt lgkmcnt(4)
    s_barrier
    v_mfma_f32_32x32x16_bf16 v[96:111], v[132:135], a[8:11], v[96:111]
    ds_read_b64_tr_b16 v[128:129], v14 offset:8192
    ds_read_b64_tr_b16 v[130:131], v14 offset:8704
    buffer_store_dwordx4 v[188:191], v30, s[24:27], s55 offen sc1
    s_add_u32 s55, s55, 16384
    v_mfma_f32_32x32x16_bf16 v[112:127], v[132:135], a[12:15], v[112:127]
    s_waitcnt lgkmcnt(4)
    v_mfma_f32_32x32x16_bf16 v[96:111], v[136:139], a[16:19], v[96:111]
    ds_read_b64_tr_b16 v[132:133], v14 offset:10240
    ds_read_b64_tr_b16 v[134:135], v14 offset:10752
    buffer_store_dwordx4 v[192:195], v30, s[24:27], s55 offen sc1
    s_add_u32 s55, s55, 16384
    v_mfma_f32_32x32x16_bf16 v[112:127], v[136:139], a[20:23], v[112:127]
    s_waitcnt lgkmcnt(4)
    v_mfma_f32_32x32x16_bf16 v[96:111], v[140:143], a[24:27], v[96:111]
    ds_read_b64_tr_b16 v[136:137], v14 offset:12288
    ds_read_b64_tr_b16 v[138:139], v14 offset:12800
    buffer_store_dwordx4 v[196:199], v30, s[24:27], s55 offen sc1
    v_mfma_f32_32x32x16_bf16 v[112:127], v[140:143], a[28:31], v[112:127]
    s_waitcnt lgkmcnt(4)
    v_mfma_f32_32x32x16_bf16 v[96:111], v[128:131], a[32:35], v[96:111]
    ds_read_b64_tr_b16 v[140:141], v14 offset:14336
    ds_read_b64_tr_b16 v[142:143], v14 offset:14848
    s_xor_b32 s52, s96, 262144
    s_add_u32 m0, s97, 65536
    s_nop 0
    buffer_load_dwordx4 v10, s[16:19], s52 offen lds
    v_mfma_f32_32x32x16_bf16 v[112:127], v[128:131], a[36:39], v[112:127]
    s_waitcnt lgkmcnt(4)
    v_mfma_f32_32x32x16_bf16 v[96:111], v[132:135], a[40:43], v[96:111]
    ds_read_b64_tr_b16 v[128:129], v14 offset:16384
    ds_read_b64_tr_b16 v[130:131], v14 offset:16896
    buffer_load_dwordx4 v11, s[16:19], s52 offen offset:1024 lds
    v_mfma_f32_32x32x16_bf16 v[112:127], v[132:135], a[44:47], v[112:127]
    s_waitcnt lgkmcnt(4)
    v_mfma_f32_32x32x16_bf16 v[96:111], v[136:139], a[48:51], v[96:111]
    ds_read_b64_tr_b16 v[132:133], v14 offset:18432
    ds_read_b64_tr_b16 v[134:135], v14 offset:18944
    buffer_load_dwordx4 v12, s[16:19], s52 offen offset:2048 lds
    v_mfma_f32_32x32x16_bf16 v[112:127], v[136:139], a[52:55], v[112:127]
    s_waitcnt lgkmcnt(4)
    v_mfma_f32_32x32x16_bf16 v[96:111], v[140:143], a[56:59], v[96:111]
    ds_read_b64_tr_b16 v[136:137], v14 offset:20480
    ds_read_b64_tr_b16 v[138:139], v14 offset:20992
    buffer_load_dwordx4 v13, s[16:19], s52 offen offset:3072 lds
    v_mfma_f32_32x32x16_bf16 v[112:127], v[140:143], a[60:63], v[112:127]
    s_waitcnt lgkmcnt(4)
    v_mfma_f32_32x32x16_bf16 v[96:111], v[128:131], a[64:67], v[96:111]
    ds_read_b64_tr_b16 v[140:141], v14 offset:22528
    ds_read_b64_tr_b16 v[142:143], v14 offset:23040
    s_xor_b32 s52, s96, 262144
    s_add_u32 s52, s52, 32768
    s_add_u32 m0, s97, 69632
    s_nop 0
    buffer_load_dwordx4 v10, s[16:19], s52 offen lds
    v_mfma_f32_32x32x16_bf16 v[112:127], v[128:131], a[68:71], v[112:127]
    s_waitcnt lgkmcnt(4)
    v_mfma_f32_32x32x16_bf16 v[96:111], v[132:135], a[72:75], v[96:111]
    ds_read_b64_tr_b16 v[128:129], v14 offset:24576
    ds_read_b64_tr_b16 v[130:131], v14 offset:25088
    buffer_load_dwordx4 v11, s[16:19], s52 offen offset:1024 lds
    v_mfma_f32_32x32x16_bf16 v[112:127], v[132:135], a[76:79], v[112:127]
    s_waitcnt lgkmcnt(4)
    v_mfma_f32_32x32x16_bf16 v[96:111], v[136:139], a[80:83], v[96:111]
    ds_read_b64_tr_b16 v[132:133], v14 offset:26624
    ds_read_b64_tr_b16 v[134:135], v14 offset:27136
    buffer_load_dwordx4 v12, s[16:19], s52 offen offset:2048 lds
    v_mfma_f32_32x32x16_bf16 v[112:127], v[136:139], a[84:87], v[112:127]
    s_waitcnt lgkmcnt(4)
    v_mfma_f32_32x32x16_bf16 v[96:111], v[140:143], a[88:91], v[96:111]
    ds_read_b64_tr_b16 v[136:137], v14 offset:28672
    ds_read_b64_tr_b16 v[138:139], v14 offset:29184
    buffer_load_dwordx4 v13, s[16:19], s52 offen offset:3072 lds
    v_mfma_f32_32x32x16_bf16 v[112:127], v[140:143], a[92:95], v[112:127]
    s_waitcnt lgkmcnt(4)
    v_mfma_f32_32x32x16_bf16 v[96:111], v[128:131], a[96:99], v[96:111]
    ds_read_b64_tr_b16 v[140:141], v14 offset:30720
    ds_read_b64_tr_b16 v[142:143], v14 offset:31232
    v_mfma_f32_32x32x16_bf16 v[112:127], v[128:131], a[100:103], v[112:127]
    s_waitcnt lgkmcnt(4)
    v_mfma_f32_32x32x16_bf16 v[96:111], v[132:135], a[104:107], v[96:111]
    ds_read_b64_tr_b16 v[128:129], v16 offset:0
    ds_read_b64_tr_b16 v[130:131], v16 offset:512
    v_mfma_f32_32x32x16_bf16 v[112:127], v[132:135], a[108:111], v[112:127]
    s_waitcnt lgkmcnt(4)
    v_mfma_f32_32x32x16_bf16 v[96:111], v[136:139], a[112:115], v[96:111]
    ds_read_b64_tr_b16 v[132:133], v16 offset:2048
    ds_read_b64_tr_b16 v[134:135], v16 offset:2560
    v_mfma_f32_32x32x16_bf16 v[112:127], v[136:139], a[116:119], v[112:127]
    s_waitcnt lgkmcnt(4)
    v_mfma_f32_32x32x16_bf16 v[96:111], v[140:143], a[120:123], v[96:111]
    ds_read_b64_tr_b16 v[136:137], v16 offset:4096
    ds_read_b64_tr_b16 v[138:139], v16 offset:4608
    v_mfma_f32_32x32x16_bf16 v[112:127], v[140:143], a[124:127], v[112:127]
    s_waitcnt lgkmcnt(4)
    v_mfma_f32_32x32x16_bf16 v[96:111], v[128:131], a[128:131], v[96:111]
    ds_read_b64_tr_b16 v[140:141], v16 offset:6144
    ds_read_b64_tr_b16 v[142:143], v16 offset:6656
    v_mfma_f32_32x32x16_bf16 v[112:127], v[128:131], a[132:135], v[112:127]
    s_waitcnt lgkmcnt(4)
    v_mfma_f32_32x32x16_bf16 v[96:111], v[132:135], a[136:139], v[96:111]
    ds_read_b64_tr_b16 v[128:129], v16 offset:8192
    ds_read_b64_tr_b16 v[130:131], v16 offset:8704
    v_mfma_f32_32x32x16_bf16 v[112:127], v[132:135], a[140:143], v[112:127]
    s_waitcnt lgkmcnt(4)
    v_mfma_f32_32x32x16_bf16 v[96:111], v[136:139], a[144:147], v[96:111]
    ds_read_b64_tr_b16 v[132:133], v16 offset:10240
    ds_read_b64_tr_b16 v[134:135], v16 offset:10752
    v_mfma_f32_32x32x16_bf16 v[112:127], v[136:139], a[148:151], v[112:127]
    s_waitcnt lgkmcnt(4)
    v_mfma_f32_32x32x16_bf16 v[96:111], v[140:143], a[152:155], v[96:111]
    ds_read_b64_tr_b16 v[136:137], v16 offset:12288
    ds_read_b64_tr_b16 v[138:139], v16 offset:12800
    s_lshl_b32 s98, s59, 16
    s_lshl_b32 s54, s43, 12
    s_add_u32 s98, s98, s54
    s_add_u32 s98, s98, 8388608
    v_lshlrev_b32 v27, 4, v1
    v_mfma_f32_32x32x16_bf16 v[112:127], v[140:143], a[156:159], v[112:127]
    s_waitcnt lgkmcnt(4)
    v_mfma_f32_32x32x16_bf16 v[96:111], v[128:131], a[160:163], v[96:111]
    ds_read_b64_tr_b16 v[140:141], v16 offset:14336
    ds_read_b64_tr_b16 v[142:143], v16 offset:14848
    buffer_load_dwordx4 v[184:187], v27, s[24:27], s98 offen offset:0 sc1
    v_mfma_f32_32x32x16_bf16 v[112:127], v[128:131], a[164:167], v[112:127]
    s_waitcnt lgkmcnt(4)
    v_mfma_f32_32x32x16_bf16 v[96:111], v[132:135], a[168:171], v[96:111]
    ds_read_b64_tr_b16 v[128:129], v16 offset:16384
    ds_read_b64_tr_b16 v[130:131], v16 offset:16896
    buffer_load_dwordx4 v[188:191], v27, s[24:27], s98 offen offset:1024 sc1
    v_mfma_f32_32x32x16_bf16 v[112:127], v[132:135], a[172:175], v[112:127]
    s_waitcnt lgkmcnt(4)
    v_mfma_f32_32x32x16_bf16 v[96:111], v[136:139], a[176:179], v[96:111]
    ds_read_b64_tr_b16 v[132:133], v16 offset:18432
    ds_read_b64_tr_b16 v[134:135], v16 offset:18944
    buffer_load_dwordx4 v[192:195], v27, s[24:27], s98 offen offset:2048 sc1
    v_mfma_f32_32x32x16_bf16 v[112:127], v[136:139], a[180:183], v[112:127]
    s_waitcnt lgkmcnt(4)
    v_mfma_f32_32x32x16_bf16 v[96:111], v[140:143], a[184:187], v[96:111]
    ds_read_b64_tr_b16 v[136:137], v16 offset:20480
    ds_read_b64_tr_b16 v[138:139], v16 offset:20992
    buffer_load_dwordx4 v[196:199], v27, s[24:27], s98 offen offset:3072 sc1
    v_mfma_f32_32x32x16_bf16 v[112:127], v[140:143], a[188:191], v[112:127]
    s_waitcnt lgkmcnt(4)
    v_mfma_f32_32x32x16_bf16 v[96:111], v[128:131], a[192:195], v[96:111]
    ds_read_b64_tr_b16 v[140:141], v16 offset:22528
    ds_read_b64_tr_b16 v[142:143], v16 offset:23040
    v_mfma_f32_32x32x16_bf16 v[112:127], v[128:131], a[196:199], v[112:127]
    s_waitcnt lgkmcnt(4)
    v_mfma_f32_32x32x16_bf16 v[96:111], v[132:135], a[200:203], v[96:111]
    ds_read_b64_tr_b16 v[128:129], v16 offset:24576
    ds_read_b64_tr_b16 v[130:131], v16 offset:25088
    v_mfma_f32_32x32x16_bf16 v[112:127], v[132:135], a[204:207], v[112:127]
    s_waitcnt lgkmcnt(4)
    v_mfma_f32_32x32x16_bf16 v[96:111], v[136:139], a[208:211], v[96:111]
    ds_read_b64_tr_b16 v[132:133], v16 offset:26624
    ds_read_b64_tr_b16 v[134:135], v16 offset:27136
    v_mfma_f32_32x32x16_bf16 v[112:127], v[136:139], a[212:215], v[112:127]
    s_waitcnt lgkmcnt(4)
    v_mfma_f32_32x32x16_bf16 v[96:111], v[140:143], a[216:219], v[96:111]
    ds_read_b64_tr_b16 v[136:137], v16 offset:28672
    ds_read_b64_tr_b16 v[138:139], v16 offset:29184
    v_mfma_f32_32x32x16_bf16 v[112:127], v[140:143], a[220:223], v[112:127]
    s_waitcnt lgkmcnt(4)
    v_mfma_f32_32x32x16_bf16 v[96:111], v[128:131], a[224:227], v[96:111]
    ds_read_b64_tr_b16 v[140:141], v16 offset:30720
    ds_read_b64_tr_b16 v[142:143], v16 offset:31232
    v_mfma_f32_32x32x16_bf16 v[112:127], v[128:131], a[228:231], v[112:127]
    s_waitcnt lgkmcnt(4)
    v_mfma_f32_32x32x16_bf16 v[96:111], v[132:135], a[232:235], v[96:111]
    v_mfma_f32_32x32x16_bf16 v[112:127], v[132:135], a[236:239], v[112:127]
    s_waitcnt lgkmcnt(2)
    v_mfma_f32_32x32x16_bf16 v[96:111], v[136:139], a[240:243], v[96:111]
    v_mfma_f32_32x32x16_bf16 v[112:127], v[136:139], a[244:247], v[112:127]
    s_waitcnt lgkmcnt(0)
    v_mfma_f32_32x32x16_bf16 v[96:111], v[140:143], a[248:251], v[96:111]
    v_mfma_f32_32x32x16_bf16 v[112:127], v[140:143], a[252:255], v[112:127]
    s_waitcnt vmcnt(0)
    s_mov_b32 s88, 32768
    v_min_u32 v28, v187, v191
    v_max_u32 v29, v187, v191
    v_min3_u32 v28, v28, v195, v199
    v_max3_u32 v29, v29, v195, v199
    v_xor_b32 v28, v26, v28
    v_xor_b32 v29, v26, v29
    v_or_b32 v28, v28, v29
    v_cmp_ne_u32 vcc, 0, v28
    s_nop 4
    s_cbranch_vccz L_h1B_ok
L_h1B:
    buffer_load_dwordx4 v[184:187], v27, s[24:27], s98 offen offset:0 sc1
    buffer_load_dwordx4 v[188:191], v27, s[24:27], s98 offen offset:1024 sc1
    buffer_load_dwordx4 v[192:195], v27, s[24:27], s98 offen offset:2048 sc1
    buffer_load_dwordx4 v[196:199], v27, s[24:27], s98 offen offset:3072 sc1
    s_waitcnt vmcnt(0)
    v_min_u32 v28, v187, v191
    v_max_u32 v29, v187, v191
    v_min3_u32 v28, v28, v195, v199
    v_max3_u32 v29, v29, v195, v199
    v_xor_b32 v28, v26, v28
    v_xor_b32 v29, v26, v29
    v_or_b32 v28, v28, v29
    v_cmp_ne_u32 vcc, 0, v28
    s_nop 4
    s_cbranch_vccz L_h1B_ok
    s_sub_u32 s88, s88, 1
    s_cmp_gt_i32 s88, 0
    s_cbranch_scc1 L_h1B
L_h1B_ok:
    v_add_f32 v216, v184, v188
    v_add_f32 v217, v185, v189
    v_add_f32 v218, v186, v190
    v_add_f32 v216, v216, v192
    v_add_f32 v217, v217, v193
    v_add_f32 v218, v218, v194
    v_add_f32 v216, v216, v196
    v_add_f32 v217, v217, v197
    v_add_f32 v218, v218, v198
    v_mov_b32 v219, v218
    s_lshl_b32 s53, s59, 11
    s_lshl_b32 s54, s43, 7
    s_add_u32 s53, s53, s54
    s_add_u32 s53, s53, 1048576
    v_permlane32_swap_b32 v216, v217
    v_permlane32_swap_b32 v218, v219
    v_add_f32 v216, v216, v217
    v_add_f32 v218, v218, v219
    v_lshlrev_b32 v27, 4, v1
    v_mov_b32 v217, v216
    v_mov_b32 v219, v218
    v_mov_b32 v223, v26
    s_nop 0
    v_permlane16_swap_b32 v216, v217
    v_permlane16_swap_b32 v218, v219
    v_add_f32 v216, v216, v217
    v_add_f32 v218, v218, v219
    v_mov_b32 v217, v216
    s_nop 0
    v_mov_b32_dpp v219, v218 quad_perm:[1,1,1,1] row_mask:0xf bank_mask:0xf
    v_permlane32_swap_b32 v216, v217
    v_mov_b32_dpp v222, v218 quad_perm:[0,0,0,0] row_mask:0xf bank_mask:0xf
    v_cvt_pk_bf16_f32 v220, v216, v217
    v_cvt_pk_bf16_f32 v222, v222, v219
    s_nop 0
    v_mov_b32_dpp v221, v220 row_ror:8 row_mask:0xf bank_mask:0xf
    s_mov_b32 exec_lo, 0xff
    s_mov_b32 exec_hi, 0
    buffer_store_dwordx4 v[220:223], v27, s[24:27], s53 offen sc1
    s_mov_b64 exec, -1
    v_cvt_pk_bf16_f32 v168, v96, v97
    v_cvt_pk_bf16_f32 v169, v98, v99
    v_cvt_pk_bf16_f32 v170, v100, v101
    v_cvt_pk_bf16_f32 v171, v102, v103
    v_cvt_pk_bf16_f32 v172, v104, v105
    v_cvt_pk_bf16_f32 v173, v106, v107
    v_mfma_f32_32x32x16_bf16 v[184:199], v[152:155], v[168:171], 0
    v_cvt_pk_bf16_f32 v174, v108, v109
    v_cvt_pk_bf16_f32 v175, v110, v111
    v_cvt_pk_bf16_f32 v176, v112, v113
    v_cvt_pk_bf16_f32 v177, v114, v115
    s_mov_b32 s52, s96
    s_add_u32 m0, s97, 98304
    s_nop 0
    buffer_load_dwordx4 v10, s[20:23], s52 offen lds
    v_mfma_f32_32x32x16_bf16 v[200:215], v[156:159], v[172:175], 0
    v_cvt_pk_bf16_f32 v178, v116, v117
    v_cvt_pk_bf16_f32 v179, v118, v119
    v_cvt_pk_bf16_f32 v180, v120, v121
    v_cvt_pk_bf16_f32 v181, v122, v123
    v_mfma_f32_32x32x16_bf16 v[216:231], v[152:155], v[176:179], 0
    v_cvt_pk_bf16_f32 v182, v124, v125
    v_cvt_pk_bf16_f32 v183, v126, v127
    s_nop 3
    buffer_load_dwordx4 v11, s[20:23], s52 offen offset:1024 lds
    v_mfma_f32_32x32x16_bf16 v[232:247], v[156:159], v[180:183], 0
    v_max3_f32 v136, v184, v185, v186
    v_max3_f32 v137, v187, v188, v189
    v_max3_f32 v136, v136, v190, v191
    v_max3_f32 v137, v137, v192, v193
    v_max3_f32 v136, v136, v194, v195
    v_max3_f32 v137, v137, v196, v197
    v_max3_f32 v136, v136, v198, v199
    v_max_f32 v136, v136, v137
    buffer_load_dwordx4 v12, s[20:23], s52 offen offset:2048 lds
    v_mul_f32 v136, s84, v136
    v_pk_fma_f32 v[184:185], v[184:185], s[84:85], v[136:137] op_sel_hi:[1,1,0] neg_lo:[0,0,1] neg_hi:[0,0,1]
    v_pk_fma_f32 v[186:187], v[186:187], s[84:85], v[136:137] op_sel_hi:[1,1,0] neg_lo:[0,0,1] neg_hi:[0,0,1]
    v_pk_fma_f32 v[188:189], v[188:189], s[84:85], v[136:137] op_sel_hi:[1,1,0] neg_lo:[0,0,1] neg_hi:[0,0,1]
    v_pk_fma_f32 v[190:191], v[190:191], s[84:85], v[136:137] op_sel_hi:[1,1,0] neg_lo:[0,0,1] neg_hi:[0,0,1]
    v_pk_fma_f32 v[192:193], v[192:193], s[84:85], v[136:137] op_sel_hi:[1,1,0] neg_lo:[0,0,1] neg_hi:[0,0,1]
    v_pk_fma_f32 v[194:195], v[194:195], s[84:85], v[136:137] op_sel_hi:[1,1,0] neg_lo:[0,0,1] neg_hi:[0,0,1]
    v_pk_fma_f32 v[196:197], v[196:197], s[84:85], v[136:137] op_sel_hi:[1,1,0] neg_lo:[0,0,1] neg_hi:[0,0,1]
    v_pk_fma_f32 v[198:199], v[198:199], s[84:85], v[136:137] op_sel_hi:[1,1,0] neg_lo:[0,0,1] neg_hi:[0,0,1]
    buffer_load_dwordx4 v13, s[20:23], s52 offen offset:3072 lds
    v_exp_f32 v184, v184
    v_exp_f32 v185, v185
    v_exp_f32 v186, v186
    v_exp_f32 v187, v187
    v_exp_f32 v188, v188
    v_exp_f32 v189, v189
    v_exp_f32 v190, v190
    v_exp_f32 v191, v191
    v_exp_f32 v192, v192
    s_mov_b32 s52, s96
    s_add_u32 s52, s52, 32768
    s_add_u32 m0, s97, 102400
    s_nop 0
    buffer_load_dwordx4 v10, s[20:23], s52 offen lds
    v_exp_f32 v193, v193
    v_exp_f32 v194, v194
    v_exp_f32 v195, v195
    v_exp_f32 v196, v196
    v_exp_f32 v197, v197
    v_exp_f32 v198, v198
    v_exp_f32 v199, v199
    v_pk_add_f32 v[138:139], v[184:185], v[186:187]
    v_pk_add_f32 v[136:137], v[188:189], v[190:191]
    buffer_load_dwordx4 v11, s[20:23], s52 offen offset:1024 lds
    v_pk_add_f32 v[138:139], v[138:139], v[192:193]
    v_pk_add_f32 v[136:137], v[136:137], v[194:195]
    v_pk_add_f32 v[138:139], v[138:139], v[196:197]
    v_pk_add_f32 v[136:137], v[136:137], v[198:199]
    v_pk_add_f32 v[138:139], v[138:139], v[136:137]
    v_add_f32 v138, v138, v139
    v_rcp_f32 v138, v138
    s_nop 0
    v_pk_mul_f32 v[184:185], v[184:185], v[138:139] op_sel_hi:[1,0]
    v_pk_mul_f32 v[186:187], v[186:187], v[138:139] op_sel_hi:[1,0]
    buffer_load_dwordx4 v12, s[20:23], s52 offen offset:2048 lds
    v_pk_mul_f32 v[188:189], v[188:189], v[138:139] op_sel_hi:[1,0]
    v_pk_mul_f32 v[190:191], v[190:191], v[138:139] op_sel_hi:[1,0]
    v_pk_mul_f32 v[192:193], v[192:193], v[138:139] op_sel_hi:[1,0]
    v_pk_mul_f32 v[194:195], v[194:195], v[138:139] op_sel_hi:[1,0]
    v_pk_mul_f32 v[196:197], v[196:197], v[138:139] op_sel_hi:[1,0]
    v_pk_mul_f32 v[198:199], v[198:199], v[138:139] op_sel_hi:[1,0]
    v_cvt_pk_bf16_f32 v32, v184, v185
    v_cvt_pk_bf16_f32 v33, v186, v187
    v_cvt_pk_bf16_f32 v34, v188, v189
    buffer_load_dwordx4 v13, s[20:23], s52 offen offset:3072 lds
    v_cvt_pk_bf16_f32 v35, v190, v191
    v_cvt_pk_bf16_f32 v36, v192, v193
    v_cvt_pk_bf16_f32 v37, v194, v195
    v_cvt_pk_bf16_f32 v38, v196, v197
    v_cvt_pk_bf16_f32 v39, v198, v199
    v_max3_f32 v136, v200, v201, v202
    v_max3_f32 v137, v203, v204, v205
    v_max3_f32 v136, v136, v206, v207
    v_max3_f32 v137, v137, v208, v209
    v_max3_f32 v136, v136, v210, v211
    v_max3_f32 v137, v137, v212, v213
    v_max3_f32 v136, v136, v214, v215
    v_max_f32 v136, v136, v137
    v_mul_f32 v136, s84, v136
    v_pk_fma_f32 v[200:201], v[200:201], s[84:85], v[136:137] op_sel_hi:[1,1,0] neg_lo:[0,0,1] neg_hi:[0,0,1]
    v_pk_fma_f32 v[202:203], v[202:203], s[84:85], v[136:137] op_sel_hi:[1,1,0] neg_lo:[0,0,1] neg_hi:[0,0,1]
    v_pk_fma_f32 v[204:205], v[204:205], s[84:85], v[136:137] op_sel_hi:[1,1,0] neg_lo:[0,0,1] neg_hi:[0,0,1]
    v_pk_fma_f32 v[206:207], v[206:207], s[84:85], v[136:137] op_sel_hi:[1,1,0] neg_lo:[0,0,1] neg_hi:[0,0,1]
    v_pk_fma_f32 v[208:209], v[208:209], s[84:85], v[136:137] op_sel_hi:[1,1,0] neg_lo:[0,0,1] neg_hi:[0,0,1]
    v_pk_fma_f32 v[210:211], v[210:211], s[84:85], v[136:137] op_sel_hi:[1,1,0] neg_lo:[0,0,1] neg_hi:[0,0,1]
    v_pk_fma_f32 v[212:213], v[212:213], s[84:85], v[136:137] op_sel_hi:[1,1,0] neg_lo:[0,0,1] neg_hi:[0,0,1]
    v_pk_fma_f32 v[214:215], v[214:215], s[84:85], v[136:137] op_sel_hi:[1,1,0] neg_lo:[0,0,1] neg_hi:[0,0,1]
    v_exp_f32 v200, v200
    v_exp_f32 v201, v201
    v_exp_f32 v202, v202
    v_exp_f32 v203, v203
    v_exp_f32 v204, v204
    v_exp_f32 v205, v205
    v_exp_f32 v206, v206
    v_exp_f32 v207, v207
    v_exp_f32 v208, v208
    v_exp_f32 v209, v209
    v_exp_f32 v210, v210
    v_exp_f32 v211, v211
    v_exp_f32 v212, v212
    v_exp_f32 v213, v213
    v_exp_f32 v214, v214
    v_exp_f32 v215, v215
    v_pk_add_f32 v[138:139], v[200:201], v[202:203]
    v_pk_add_f32 v[136:137], v[204:205], v[206:207]
    v_pk_add_f32 v[138:139], v[138:139], v[208:209]
    v_pk_add_f32 v[136:137], v[136:137], v[210:211]
    v_pk_add_f32 v[138:139], v[138:139], v[212:213]
    v_pk_add_f32 v[136:137], v[136:137], v[214:215]
    v_pk_add_f32 v[138:139], v[138:139], v[136:137]
    v_add_f32 v138, v138, v139
    v_rcp_f32 v138, v138
    s_nop 0
    v_pk_mul_f32 v[200:201], v[200:201], v[138:139] op_sel_hi:[1,0]
    v_pk_mul_f32 v[202:203], v[202:203], v[138:139] op_sel_hi:[1,0]
    s_lshl_b32 s100, s59, 11
    s_add_u32 s100, s100, 1048576
    s_xor_b32 s101, s100, 2048
    s_mov_b32 s98, 0xff00ff00
    s_mov_b32 s99, 0xff00ff00
    v_pk_mul_f32 v[204:205], v[204:205], v[138:139] op_sel_hi:[1,0]
    v_lshrrev_b32 v31, 4, v1
    v_lshlrev_b32 v31, 7, v31
    v_and_b32 v30, 7, v1
    v_lshl_add_u32 v31, v30, 4, v31
    v_pk_mul_f32 v[206:207], v[206:207], v[138:139] op_sel_hi:[1,0]
    buffer_load_dwordx4 v[64:67], v31, s[24:27], s100 offen offset:0 sc1
    v_pk_mul_f32 v[208:209], v[208:209], v[138:139] op_sel_hi:[1,0]
    buffer_load_dwordx4 v[68:71], v31, s[24:27], s100 offen offset:512 sc1
    v_pk_mul_f32 v[210:211], v[210:211], v[138:139] op_sel_hi:[1,0]
    buffer_load_dwordx4 v[72:75], v31, s[24:27], s100 offen offset:1024 sc1
    v_pk_mul_f32 v[212:213], v[212:213], v[138:139] op_sel_hi:[1,0]
    buffer_load_dwordx4 v[76:79], v31, s[24:27], s100 offen offset:1536 sc1
    v_pk_mul_f32 v[214:215], v[214:215], v[138:139] op_sel_hi:[1,0]
    buffer_load_dwordx4 v[80:83], v31, s[24:27], s101 offen offset:0 sc1
    v_cvt_pk_bf16_f32 v40, v200, v201
    buffer_load_dwordx4 v[84:87], v31, s[24:27], s101 offen offset:512 sc1
    v_cvt_pk_bf16_f32 v41, v202, v203
    buffer_load_dwordx4 v[88:91], v31, s[24:27], s101 offen offset:1024 sc1
    v_cvt_pk_bf16_f32 v42, v204, v205
    buffer_load_dwordx4 v[92:95], v31, s[24:27], s101 offen offset:1536 sc1
    v_cvt_pk_bf16_f32 v43, v206, v207
    v_cvt_pk_bf16_f32 v44, v208, v209
    v_cvt_pk_bf16_f32 v45, v210, v211
    v_cvt_pk_bf16_f32 v46, v212, v213
    v_cvt_pk_bf16_f32 v47, v214, v215
    v_max3_f32 v136, v216, v217, v218
    v_max3_f32 v137, v219, v220, v221
    v_max3_f32 v136, v136, v222, v223
    v_max3_f32 v137, v137, v224, v225
    v_max3_f32 v136, v136, v226, v227
    v_max3_f32 v137, v137, v228, v229
    v_max3_f32 v136, v136, v230, v231
    v_max_f32 v136, v136, v137
    v_mul_f32 v136, s84, v136
    v_pk_fma_f32 v[216:217], v[216:217], s[84:85], v[136:137] op_sel_hi:[1,1,0] neg_lo:[0,0,1] neg_hi:[0,0,1]
    v_pk_fma_f32 v[218:219], v[218:219], s[84:85], v[136:137] op_sel_hi:[1,1,0] neg_lo:[0,0,1] neg_hi:[0,0,1]
    v_pk_fma_f32 v[220:221], v[220:221], s[84:85], v[136:137] op_sel_hi:[1,1,0] neg_lo:[0,0,1] neg_hi:[0,0,1]
    v_pk_fma_f32 v[222:223], v[222:223], s[84:85], v[136:137] op_sel_hi:[1,1,0] neg_lo:[0,0,1] neg_hi:[0,0,1]
    v_pk_fma_f32 v[224:225], v[224:225], s[84:85], v[136:137] op_sel_hi:[1,1,0] neg_lo:[0,0,1] neg_hi:[0,0,1]
    v_pk_fma_f32 v[226:227], v[226:227], s[84:85], v[136:137] op_sel_hi:[1,1,0] neg_lo:[0,0,1] neg_hi:[0,0,1]
    v_pk_fma_f32 v[228:229], v[228:229], s[84:85], v[136:137] op_sel_hi:[1,1,0] neg_lo:[0,0,1] neg_hi:[0,0,1]
    v_pk_fma_f32 v[230:231], v[230:231], s[84:85], v[136:137] op_sel_hi:[1,1,0] neg_lo:[0,0,1] neg_hi:[0,0,1]
    v_exp_f32 v216, v216
    v_exp_f32 v217, v217
    v_exp_f32 v218, v218
    v_exp_f32 v219, v219
    v_exp_f32 v220, v220
    v_exp_f32 v221, v221
    v_exp_f32 v222, v222
    v_exp_f32 v223, v223
    v_exp_f32 v224, v224
    v_exp_f32 v225, v225
    v_exp_f32 v226, v226
    v_exp_f32 v227, v227
    v_exp_f32 v228, v228
    v_exp_f32 v229, v229
    v_exp_f32 v230, v230
    v_exp_f32 v231, v231
    v_pk_add_f32 v[138:139], v[216:217], v[218:219]
    v_pk_add_f32 v[136:137], v[220:221], v[222:223]
    v_pk_add_f32 v[138:139], v[138:139], v[224:225]
    v_pk_add_f32 v[136:137], v[136:137], v[226:227]
    v_pk_add_f32 v[138:139], v[138:139], v[228:229]
    v_pk_add_f32 v[136:137], v[136:137], v[230:231]
    v_pk_add_f32 v[138:139], v[138:139], v[136:137]
    v_add_f32 v138, v138, v139
    v_rcp_f32 v138, v138
    s_nop 0
    v_pk_mul_f32 v[216:217], v[216:217], v[138:139] op_sel_hi:[1,0]
    v_pk_mul_f32 v[218:219], v[218:219], v[138:139] op_sel_hi:[1,0]
    v_pk_mul_f32 v[220:221], v[220:221], v[138:139] op_sel_hi:[1,0]
    v_pk_mul_f32 v[222:223], v[222:223], v[138:139] op_sel_hi:[1,0]
    v_pk_mul_f32 v[224:225], v[224:225], v[138:139] op_sel_hi:[1,0]
    v_pk_mul_f32 v[226:227], v[226:227], v[138:139] op_sel_hi:[1,0]
    v_pk_mul_f32 v[228:229], v[228:229], v[138:139] op_sel_hi:[1,0]
    v_pk_mul_f32 v[230:231], v[230:231], v[138:139] op_sel_hi:[1,0]
    v_cvt_pk_bf16_f32 v48, v216, v217
    v_cvt_pk_bf16_f32 v49, v218, v219
    v_cvt_pk_bf16_f32 v50, v220, v221
    v_cvt_pk_bf16_f32 v51, v222, v223
    v_cvt_pk_bf16_f32 v52, v224, v225
    v_cvt_pk_bf16_f32 v53, v226, v227
    v_cvt_pk_bf16_f32 v54, v228, v229
    v_cvt_pk_bf16_f32 v55, v230, v231
    v_max3_f32 v136, v232, v233, v234
    v_max3_f32 v137, v235, v236, v237
    v_max3_f32 v136, v136, v238, v239
    v_max3_f32 v137, v137, v240, v241
    v_max3_f32 v136, v136, v242, v243
    v_max3_f32 v137, v137, v244, v245
    v_max3_f32 v136, v136, v246, v247
    v_max_f32 v136, v136, v137
    v_mul_f32 v136, s84, v136
    v_pk_fma_f32 v[232:233], v[232:233], s[84:85], v[136:137] op_sel_hi:[1,1,0] neg_lo:[0,0,1] neg_hi:[0,0,1]
    v_pk_fma_f32 v[234:235], v[234:235], s[84:85], v[136:137] op_sel_hi:[1,1,0] neg_lo:[0,0,1] neg_hi:[0,0,1]
    v_pk_fma_f32 v[236:237], v[236:237], s[84:85], v[136:137] op_sel_hi:[1,1,0] neg_lo:[0,0,1] neg_hi:[0,0,1]
    v_pk_fma_f32 v[238:239], v[238:239], s[84:85], v[136:137] op_sel_hi:[1,1,0] neg_lo:[0,0,1] neg_hi:[0,0,1]
    v_pk_fma_f32 v[240:241], v[240:241], s[84:85], v[136:137] op_sel_hi:[1,1,0] neg_lo:[0,0,1] neg_hi:[0,0,1]
    v_pk_fma_f32 v[242:243], v[242:243], s[84:85], v[136:137] op_sel_hi:[1,1,0] neg_lo:[0,0,1] neg_hi:[0,0,1]
    v_pk_fma_f32 v[244:245], v[244:245], s[84:85], v[136:137] op_sel_hi:[1,1,0] neg_lo:[0,0,1] neg_hi:[0,0,1]
    v_pk_fma_f32 v[246:247], v[246:247], s[84:85], v[136:137] op_sel_hi:[1,1,0] neg_lo:[0,0,1] neg_hi:[0,0,1]
    v_exp_f32 v232, v232
    v_exp_f32 v233, v233
    v_exp_f32 v234, v234
    v_exp_f32 v235, v235
    v_exp_f32 v236, v236
    v_exp_f32 v237, v237
    v_exp_f32 v238, v238
    v_exp_f32 v239, v239
    v_exp_f32 v240, v240
    v_exp_f32 v241, v241
    v_exp_f32 v242, v242
    v_exp_f32 v243, v243
    v_exp_f32 v244, v244
    v_exp_f32 v245, v245
    v_exp_f32 v246, v246
    v_exp_f32 v247, v247
    v_pk_add_f32 v[138:139], v[232:233], v[234:235]
    v_pk_add_f32 v[136:137], v[236:237], v[238:239]
    v_pk_add_f32 v[138:139], v[138:139], v[240:241]
    v_pk_add_f32 v[136:137], v[136:137], v[242:243]
    v_pk_add_f32 v[138:139], v[138:139], v[244:245]
    v_pk_add_f32 v[136:137], v[136:137], v[246:247]
    v_pk_add_f32 v[138:139], v[138:139], v[136:137]
    v_add_f32 v138, v138, v139
    v_rcp_f32 v138, v138
    s_nop 0
    v_pk_mul_f32 v[232:233], v[232:233], v[138:139] op_sel_hi:[1,0]
    v_pk_mul_f32 v[234:235], v[234:235], v[138:139] op_sel_hi:[1,0]
    v_pk_mul_f32 v[236:237], v[236:237], v[138:139] op_sel_hi:[1,0]
    v_pk_mul_f32 v[238:239], v[238:239], v[138:139] op_sel_hi:[1,0]
    v_pk_mul_f32 v[240:241], v[240:241], v[138:139] op_sel_hi:[1,0]
    v_pk_mul_f32 v[242:243], v[242:243], v[138:139] op_sel_hi:[1,0]
    v_pk_mul_f32 v[244:245], v[244:245], v[138:139] op_sel_hi:[1,0]
    v_pk_mul_f32 v[246:247], v[246:247], v[138:139] op_sel_hi:[1,0]
    v_cvt_pk_bf16_f32 v56, v232, v233
    v_cvt_pk_bf16_f32 v57, v234, v235
    v_cvt_pk_bf16_f32 v58, v236, v237
    v_cvt_pk_bf16_f32 v59, v238, v239
    v_cvt_pk_bf16_f32 v60, v240, v241
    v_cvt_pk_bf16_f32 v61, v242, v243
    v_cvt_pk_bf16_f32 v62, v244, v245
    v_cvt_pk_bf16_f32 v63, v246, v247
    s_mov_b32 s88, 32768
    s_waitcnt vmcnt(0)
    v_min_u32 v28, v67, v71
    v_max_u32 v29, v67, v71
    v_min3_u32 v28, v28, v75, v79
    v_max3_u32 v29, v29, v75, v79
    v_min3_u32 v28, v28, v83, v87
    v_max3_u32 v29, v29, v83, v87
    v_min3_u32 v28, v28, v91, v95
    v_max3_u32 v29, v29, v91, v95
    v_xor_b32 v28, v26, v28
    v_xor_b32 v29, v26, v29
    v_or_b32 v28, v28, v29
    v_cmp_ne_u32 vcc, 0, v28
    s_nop 4
    s_cbranch_vccz L_h2B_ok
L_h2B:
    buffer_load_dwordx4 v[64:67], v31, s[24:27], s100 offen offset:0 sc1
    buffer_load_dwordx4 v[68:71], v31, s[24:27], s100 offen offset:512 sc1
    buffer_load_dwordx4 v[72:75], v31, s[24:27], s100 offen offset:1024 sc1
    buffer_load_dwordx4 v[76:79], v31, s[24:27], s100 offen offset:1536 sc1
    buffer_load_dwordx4 v[80:83], v31, s[24:27], s101 offen offset:0 sc1
    buffer_load_dwordx4 v[84:87], v31, s[24:27], s101 offen offset:512 sc1
    buffer_load_dwordx4 v[88:91], v31, s[24:27], s101 offen offset:1024 sc1
    buffer_load_dwordx4 v[92:95], v31, s[24:27], s101 offen offset:1536 sc1
    s_waitcnt vmcnt(0)
    v_min_u32 v28, v67, v71
    v_max_u32 v29, v67, v71
    v_min3_u32 v28, v28, v75, v79
    v_max3_u32 v29, v29, v75, v79
    v_min3_u32 v28, v28, v83, v87
    v_max3_u32 v29, v29, v83, v87
    v_min3_u32 v28, v28, v91, v95
    v_max3_u32 v29, v29, v91, v95
    v_xor_b32 v28, v26, v28
    v_xor_b32 v29, v26, v29
    v_or_b32 v28, v28, v29
    v_cmp_ne_u32 vcc, 0, v28
    s_nop 4
    s_cbranch_vccz L_h2B_ok
    s_sub_u32 s88, s88, 1
    s_cmp_gt_i32 s88, 0
    s_cbranch_scc1 L_h2B
L_h2B_ok:
    v_cndmask_b32_e64 v216, v64, v65, s[98:99]
    v_cndmask_b32_e64 v217, v68, v69, s[98:99]
    v_cndmask_b32_e64 v218, v72, v73, s[98:99]
    v_cndmask_b32_e64 v219, v76, v77, s[98:99]
    v_mov_b32 v220, v66
    v_mov_b32 v221, v70
    v_mov_b32 v222, v74
    v_mov_b32 v223, v78
    v_cndmask_b32_e64 v224, v80, v81, s[98:99]
    v_cndmask_b32_e64 v225, v84, v85, s[98:99]
    v_cndmask_b32_e64 v226, v88, v89, s[98:99]
    v_cndmask_b32_e64 v227, v92, v93, s[98:99]
    v_mov_b32 v228, v82
    v_mov_b32 v229, v86
    v_mov_b32 v230, v90
    v_mov_b32 v231, v94
    v_permlane16_swap_b32 v216, v220
    v_permlane16_swap_b32 v217, v221
    v_permlane16_swap_b32 v218, v222
    v_permlane16_swap_b32 v219, v223
    v_permlane16_swap_b32 v224, v228
    v_permlane16_swap_b32 v225, v229
    v_permlane16_swap_b32 v226, v230
    v_permlane16_swap_b32 v227, v231
    v_mfma_f32_32x32x16_bf16 v[64:79], v[216:219], v[32:35], 0
    v_mfma_f32_32x32x16_bf16 v[64:79], v[220:223], v[36:39], v[64:79]
    s_lshl_b32 s53, s43, 2
    s_lshl_b32 s54, s41, 1
    s_add_u32 s53, s53, s54
    s_lshl_b32 s53, s53, 16
    s_lshl_b32 s54, s59, 10
    s_add_u32 s53, s53, s54
    s_add_u32 s53, s53, 2097152
    s_xor_b32 s54, s53, 1024
    s_add_u32 s55, s53, 65536
    s_add_u32 s56, s54, 65536
    v_lshlrev_b32 v27, 4, v1
    v_mfma_f32_32x32x16_bf16 v[80:95], v[224:227], v[40:43], 0
    v_mfma_f32_32x32x16_bf16 v[80:95], v[228:231], v[44:47], v[80:95]
    v_mfma_f32_32x32x16_bf16 v[96:111], v[216:219], v[48:51], 0
    v_mfma_f32_32x32x16_bf16 v[96:111], v[220:223], v[52:55], v[96:111]
    v_mfma_f32_32x32x16_bf16 v[112:127], v[224:227], v[56:59], 0
    v_mfma_f32_32x32x16_bf16 v[112:127], v[228:231], v[60:63], v[112:127]
    v_add_f32 v72, s86, v72
    v_rcp_f32 v72, v72
    s_nop 0
    v_pk_mul_f32 v[64:65], v[64:65], v[72:73] op_sel_hi:[1,0]
    v_pk_mul_f32 v[66:67], v[66:67], v[72:73] op_sel_hi:[1,0]
    v_pk_mul_f32 v[68:69], v[68:69], v[72:73] op_sel_hi:[1,0]
    v_pk_mul_f32 v[70:71], v[70:71], v[72:73] op_sel_hi:[1,0]
    v_cvt_pk_bf16_f32 v232, v64, v65
    v_cvt_pk_bf16_f32 v233, v66, v67
    v_cvt_pk_bf16_f32 v234, v68, v69
    v_cvt_pk_bf16_f32 v235, v70, v71
    buffer_store_dwordx4 v[232:235], v27, s[24:27], s53 offen sc1
    v_add_f32 v88, s86, v88
    v_rcp_f32 v88, v88
    s_nop 0
    v_pk_mul_f32 v[80:81], v[80:81], v[88:89] op_sel_hi:[1,0]
    v_pk_mul_f32 v[82:83], v[82:83], v[88:89] op_sel_hi:[1,0]
    v_pk_mul_f32 v[84:85], v[84:85], v[88:89] op_sel_hi:[1,0]
    v_pk_mul_f32 v[86:87], v[86:87], v[88:89] op_sel_hi:[1,0]
    v_cvt_pk_bf16_f32 v236, v80, v81
    v_cvt_pk_bf16_f32 v237, v82, v83
    v_cvt_pk_bf16_f32 v238, v84, v85
    v_cvt_pk_bf16_f32 v239, v86, v87
    buffer_store_dwordx4 v[236:239], v27, s[24:27], s54 offen sc1
    v_add_f32 v104, s86, v104
    v_rcp_f32 v104, v104
    s_nop 0
    v_pk_mul_f32 v[96:97], v[96:97], v[104:105] op_sel_hi:[1,0]
    v_pk_mul_f32 v[98:99], v[98:99], v[104:105] op_sel_hi:[1,0]
    v_pk_mul_f32 v[100:101], v[100:101], v[104:105] op_sel_hi:[1,0]
    v_pk_mul_f32 v[102:103], v[102:103], v[104:105] op_sel_hi:[1,0]
    v_cvt_pk_bf16_f32 v240, v96, v97
    v_cvt_pk_bf16_f32 v241, v98, v99
    v_cvt_pk_bf16_f32 v242, v100, v101
    v_cvt_pk_bf16_f32 v243, v102, v103
    buffer_store_dwordx4 v[240:243], v27, s[24:27], s55 offen sc1
    v_add_f32 v120, s86, v120
    v_rcp_f32 v120, v120
    s_nop 0
    v_pk_mul_f32 v[112:113], v[112:113], v[120:121] op_sel_hi:[1,0]
    v_pk_mul_f32 v[114:115], v[114:115], v[120:121] op_sel_hi:[1,0]
    v_pk_mul_f32 v[116:117], v[116:117], v[120:121] op_sel_hi:[1,0]
    v_pk_mul_f32 v[118:119], v[118:119], v[120:121] op_sel_hi:[1,0]
    v_cvt_pk_bf16_f32 v244, v112, v113
    v_cvt_pk_bf16_f32 v245, v114, v115
    v_cvt_pk_bf16_f32 v246, v116, v117
    v_cvt_pk_bf16_f32 v247, v118, v119
    buffer_store_dwordx4 v[244:247], v27, s[24:27], s56 offen sc1
    s_lshl_b32 s53, s43, 1
    s_add_u32 s53, s53, s41
    s_lshl_b32 s53, s53, 5
    s_lshl_b32 s54, s44, 1
    s_add_u32 s53, s53, s54
    s_add_u32 s53, s53, s42
    s_add_u32 s53, s53, 16
    s_lshl_b32 s53, s53, 7
    s_add_u32 s100, s53, 131072
    s_barrier
    v_lshrrev_b32 v27, 5, v1
    v_lshlrev_b32 v27, 2, v27
    v_bfe_u32 v28, v1, 2, 2
    v_add_u32 v27, v27, v28
    v_lshlrev_b32 v27, 7, v27
    v_bfe_u32 v29, v1, 4, 1
    v_lshl_add_u32 v27, v29, 5, v27
    v_and_b32 v29, 3, v1
    v_lshl_add_u32 v27, v29, 3, v27
    s_and_b32 s53, s6, 1
    s_xor_b32 s53, s53, s42
    s_lshl_b32 s53, s53, 16
    s_add_u32 s53, s53, 32768
    v_add_u32 v27, s53, v27
    v_lshrrev_b32 v28, 1, v28
    v_lshl_add_u32 v2, v28, 6, v27
    v_xor_b32 v28, 1, v28
    v_lshl_add_u32 v3, v28, 6, v27
    v_and_b32 v27, 31, v1
    s_lshl_b32 s53, s42, 14
    s_lshl_b32 s54, s41, 13
    s_add_u32 s53, s53, s54
    v_lshlrev_b32 v28, 8, v27
    v_add_u32 v28, s53, v28
    v_and_b32 v29, 7, v27
    v_lshrrev_b32 v27, 5, v1
    v_xor_b32 v29, v29, v27
    v_xor_b32 v27, 0, v29
    v_lshl_add_u32 v4, v27, 4, v28
    v_xor_b32 v27, 2, v29
    v_lshl_add_u32 v5, v27, 4, v28
    v_xor_b32 v27, 4, v29
    v_lshl_add_u32 v6, v27, 4, v28
    v_xor_b32 v27, 6, v29
    v_lshl_add_u32 v7, v27, 4, v28
    v_lshrrev_b32 v27, 3, v1
    v_and_b32 v28, 7, v1
    v_lshlrev_b32 v28, 1, v28
    s_lshl_b32 s53, s40, 12
    v_lshlrev_b32 v29, 8, v27
    v_add_u32 v29, s53, v29
    v_or_b32 v30, 0, v28
    v_xor_b32 v30, v30, v27
    v_lshl_add_u32 v8, v30, 4, v29
    v_or_b32 v30, 1, v28
    v_xor_b32 v30, v30, v27
    v_lshl_add_u32 v9, v30, 4, v29
    v_and_b32 v28, 7, v1
    v_lshlrev_b32 v28, 4, v28
    v_lshl_add_u32 v14, v27, 10, v28
    v_and_b32 v15, 15, v1
    v_lshlrev_b32 v15, 7, v15
    v_lshlrev_b32 v16, 4, v1
    v_and_b32 v28, 31, v1
    v_lshrrev_b32 v29, 2, v28
    v_lshlrev_b32 v29, 7, v29
    v_and_b32 v28, 3, v28
    v_lshl_add_u32 v17, v28, 3, v29
    s_lshl_b32 s53, s57, 1
    s_add_u32 s53, s53, s42
    s_lshl_b32 s53, s53, 11
    s_add_u32 s47, s53, 131072
    s_lshl_b32 s53, s57, 1
    s_add_u32 s53, s53, s41
    s_lshl_b32 s54, s53, 16
    s_lshl_b32 s55, s42, 15
    s_add_u32 s54, s54, s55
    s_add_u32 s48, s54, 2097152
    s_lshl_b32 s53, s53, 10
    s_add_u32 s49, s53, 4096
    s_lshl_b32 s53, s57, 6
    s_lshl_b32 s54, s40, 4
    s_add_u32 s53, s53, s54
    s_lshl_b32 s53, s53, 10
    s_lshl_b32 s54, s58, 7
    s_add_u32 s50, s53, s54
    s_add_u32 s51, s50, 8192
    s_mov_b32 s7, s58
    s_lshr_b32 s3, s6, 1
    s_lshl_b32 s3, s3, 2
    v_mov_b32 v27, 0
    s_waitcnt vmcnt(0)
    s_mov_b64 exec, 1
    buffer_store_dword v26, v27, s[24:27], s100 offen sc1
    s_mov_b64 exec, -1
    s_xor_b32 s52, s96, 262144
    s_add_u32 m0, s97, 131072
    s_nop 0
    buffer_load_dwordx4 v10, s[20:23], s52 offen lds
    buffer_load_dwordx4 v11, s[20:23], s52 offen offset:1024 lds
    buffer_load_dwordx4 v12, s[20:23], s52 offen offset:2048 lds
    buffer_load_dwordx4 v13, s[20:23], s52 offen offset:3072 lds
    s_xor_b32 s52, s96, 262144
    s_add_u32 s52, s52, 32768
    s_add_u32 m0, s97, 135168
    s_nop 0
    buffer_load_dwordx4 v10, s[20:23], s52 offen lds
    buffer_load_dwordx4 v11, s[20:23], s52 offen offset:1024 lds
    buffer_load_dwordx4 v12, s[20:23], s52 offen offset:2048 lds
    buffer_load_dwordx4 v13, s[20:23], s52 offen offset:3072 lds
    s_waitcnt vmcnt(0)
    s_barrier
    buffer_load_dwordx2 v[96:97], v17, s[24:27], s49 offen sc1
    s_mov_b32 s88, 32768
L_flB:
    buffer_load_dword v28, v15, s[24:27], s47 offen sc1
    s_waitcnt vmcnt(0)
    v_cmp_ne_u32 vcc, v28, v26
    s_nop 4
    s_cbranch_vccz L_flB_ok
    s_sub_u32 s88, s88, 1
    s_cmp_gt_i32 s88, 0
    s_cbranch_scc1 L_flB
L_flB_ok:
    s_add_u32 s55, s7, 0
    s_and_b32 s55, s55, 7
    s_add_u32 s55, s55, s3
    s_and_b32 s55, s55, 7
    s_lshl_b32 s55, s55, 12
    s_add_u32 s54, s48, s55
    buffer_load_dwordx4 a[0:3], v16, s[24:27], s54 offen offset:0 sc1
    buffer_load_dwordx4 a[4:7], v16, s[24:27], s54 offen offset:1024 sc1
    buffer_load_dwordx4 a[8:11], v16, s[24:27], s54 offen offset:2048 sc1
    buffer_load_dwordx4 a[12:15], v16, s[24:27], s54 offen offset:3072 sc1
    s_add_u32 s55, s7, 1
    s_and_b32 s55, s55, 7
    s_add_u32 s55, s55, s3
    s_and_b32 s55, s55, 7
    s_lshl_b32 s55, s55, 12
    s_add_u32 s54, s48, s55
    buffer_load_dwordx4 a[16:19], v16, s[24:27], s54 offen offset:0 sc1
    buffer_load_dwordx4 a[20:23], v16, s[24:27], s54 offen offset:1024 sc1
    buffer_load_dwordx4 a[24:27], v16, s[24:27], s54 offen offset:2048 sc1
    buffer_load_dwordx4 a[28:31], v16, s[24:27], s54 offen offset:3072 sc1
    s_add_u32 s55, s7, 2
    s_and_b32 s55, s55, 7
    s_add_u32 s55, s55, s3
    s_and_b32 s55, s55, 7
    s_lshl_b32 s55, s55, 12
    s_add_u32 s54, s48, s55
    buffer_load_dwordx4 a[32:35], v16, s[24:27], s54 offen offset:0 sc1
    buffer_load_dwordx4 a[36:39], v16, s[24:27], s54 offen offset:1024 sc1
    buffer_load_dwordx4 a[40:43], v16, s[24:27], s54 offen offset:2048 sc1
    buffer_load_dwordx4 a[44:47], v16, s[24:27], s54 offen offset:3072 sc1
    s_add_u32 s53, s7, 0
    s_and_b32 s53, s53, 7
    s_lshl_b32 s53, s53, 13
    v_add_u32 v18, s53, v2
    v_add_u32 v19, s53, v3
    ds_read_b64_tr_b16 v[128:129], v18 offset:0
    ds_read_b64_tr_b16 v[130:131], v18 offset:1024
    ds_read_b64_tr_b16 v[132:133], v19 offset:0
    ds_read_b64_tr_b16 v[134:135], v19 offset:1024
    ds_read_b64_tr_b16 v[136:137], v18 offset:2048
    ds_read_b64_tr_b16 v[138:139], v18 offset:3072
    ds_read_b64_tr_b16 v[140:141], v19 offset:2048
    ds_read_b64_tr_b16 v[142:143], v19 offset:3072
    s_mov_b32 s88, 32768
    v_cmp_ne_u32 vcc, v97, v26
    s_nop 4
    s_cbranch_vccz L_gB_ok
L_gB:
    buffer_load_dwordx2 v[96:97], v17, s[24:27], s49 offen sc1
    s_waitcnt vmcnt(0)
    v_cmp_ne_u32 vcc, v97, v26
    s_nop 4
    s_cbranch_vccz L_gB_ok
    s_sub_u32 s88, s88, 1
    s_cmp_gt_i32 s88, 0
    s_cbranch_scc1 L_gB
L_gB_ok:
    v_sub_f32 v97, 1.0, v96
    s_cmp_eq_u32 s42, 0
    s_cselect_b64 vcc, 0, -1
    v_cndmask_b32 v96, v96, v97, vcc
    s_waitcnt vmcnt(11) lgkmcnt(4)
    v_mfma_f32_32x32x16_bf16 v[64:79], v[128:131], a[0:3], 0
    ds_read_b64_tr_b16 v[144:145], v18 offset:4096
    ds_read_b64_tr_b16 v[146:147], v18 offset:5120
    s_add_u32 s55, s7, 3
    s_and_b32 s55, s55, 7
    s_add_u32 s55, s55, s3
    s_and_b32 s55, s55, 7
    s_lshl_b32 s55, s55, 12
    s_add_u32 s54, s48, s55
    buffer_load_dwordx4 a[48:51], v16, s[24:27], s54 offen offset:0 sc1
    v_mfma_f32_32x32x16_bf16 v[80:95], v[132:135], a[0:3], 0
    ds_read_b64_tr_b16 v[148:149], v19 offset:4096
    ds_read_b64_tr_b16 v[150:151], v19 offset:5120
    s_waitcnt vmcnt(11) lgkmcnt(4)
    v_mfma_f32_32x32x16_bf16 v[64:79], v[136:139], a[4:7], v[64:79]
    ds_read_b64_tr_b16 v[128:129], v18 offset:6144
    ds_read_b64_tr_b16 v[130:131], v18 offset:7168
    buffer_load_dwordx4 a[52:55], v16, s[24:27], s54 offen offset:1024 sc1
    v_mfma_f32_32x32x16_bf16 v[80:95], v[140:143], a[4:7], v[80:95]
    ds_read_b64_tr_b16 v[132:133], v19 offset:6144
    ds_read_b64_tr_b16 v[134:135], v19 offset:7168
    s_waitcnt vmcnt(11) lgkmcnt(4)
    v_mfma_f32_32x32x16_bf16 v[64:79], v[144:147], a[8:11], v[64:79]
    s_add_u32 s53, s7, 1
    s_and_b32 s53, s53, 7
    s_lshl_b32 s53, s53, 13
    v_add_u32 v20, s53, v2
    v_add_u32 v21, s53, v3
    ds_read_b64_tr_b16 v[136:137], v20 offset:0
    ds_read_b64_tr_b16 v[138:139], v20 offset:1024
    buffer_load_dwordx4 a[56:59], v16, s[24:27], s54 offen offset:2048 sc1
    v_mfma_f32_32x32x16_bf16 v[80:95], v[148:151], a[8:11], v[80:95]
    ds_read_b64_tr_b16 v[140:141], v21 offset:0
    ds_read_b64_tr_b16 v[142:143], v21 offset:1024
    s_waitcnt vmcnt(11) lgkmcnt(4)
    v_mfma_f32_32x32x16_bf16 v[64:79], v[128:131], a[12:15], v[64:79]
    ds_read_b64_tr_b16 v[144:145], v20 offset:2048
    ds_read_b64_tr_b16 v[146:147], v20 offset:3072
    buffer_load_dwordx4 a[60:63], v16, s[24:27], s54 offen offset:3072 sc1
    v_mfma_f32_32x32x16_bf16 v[80:95], v[132:135], a[12:15], v[80:95]
    ds_read_b64_tr_b16 v[148:149], v21 offset:2048
    ds_read_b64_tr_b16 v[150:151], v21 offset:3072
    s_waitcnt vmcnt(11) lgkmcnt(4)
    v_mfma_f32_32x32x16_bf16 v[64:79], v[136:139], a[16:19], v[64:79]
    ds_read_b64_tr_b16 v[128:129], v20 offset:4096
    ds_read_b64_tr_b16 v[130:131], v20 offset:5120
    s_add_u32 s55, s7, 4
    s_and_b32 s55, s55, 7
    s_add_u32 s55, s55, s3
    s_and_b32 s55, s55, 7
    s_lshl_b32 s55, s55, 12
    s_add_u32 s54, s48, s55
    buffer_load_dwordx4 a[64:67], v16, s[24:27], s54 offen offset:0 sc1
    v_mfma_f32_32x32x16_bf16 v[80:95], v[140:143], a[16:19], v[80:95]
    ds_read_b64_tr_b16 v[132:133], v21 offset:4096
    ds_read_b64_tr_b16 v[134:135], v21 offset:5120
    s_waitcnt vmcnt(11) lgkmcnt(4)
    v_mfma_f32_32x32x16_bf16 v[64:79], v[144:147], a[20:23], v[64:79]
    ds_read_b64_tr_b16 v[136:137], v20 offset:6144
    ds_read_b64_tr_b16 v[138:139], v20 offset:7168
    buffer_load_dwordx4 a[68:71], v16, s[24:27], s54 offen offset:1024 sc1
    v_mfma_f32_32x32x16_bf16 v[80:95], v[148:151], a[20:23], v[80:95]
    ds_read_b64_tr_b16 v[140:141], v21 offset:6144
    ds_read_b64_tr_b16 v[142:143], v21 offset:7168
    s_waitcnt vmcnt(11) lgkmcnt(4)
    v_mfma_f32_32x32x16_bf16 v[64:79], v[128:131], a[24:27], v[64:79]
    s_add_u32 s53, s7, 2
    s_and_b32 s53, s53, 7
    s_lshl_b32 s53, s53, 13
    v_add_u32 v18, s53, v2
    v_add_u32 v19, s53, v3
    ds_read_b64_tr_b16 v[144:145], v18 offset:0
    ds_read_b64_tr_b16 v[146:147], v18 offset:1024
    buffer_load_dwordx4 a[72:75], v16, s[24:27], s54 offen offset:2048 sc1
    v_mfma_f32_32x32x16_bf16 v[80:95], v[132:135], a[24:27], v[80:95]
    ds_read_b64_tr_b16 v[148:149], v19 offset:0
    ds_read_b64_tr_b16 v[150:151], v19 offset:1024
    s_waitcnt vmcnt(11) lgkmcnt(4)
    v_mfma_f32_32x32x16_bf16 v[64:79], v[136:139], a[28:31], v[64:79]
    ds_read_b64_tr_b16 v[128:129], v18 offset:2048
    ds_read_b64_tr_b16 v[130:131], v18 offset:3072
    buffer_load_dwordx4 a[76:79], v16, s[24:27], s54 offen offset:3072 sc1
    v_mfma_f32_32x32x16_bf16 v[80:95], v[140:143], a[28:31], v[80:95]
    ds_read_b64_tr_b16 v[132:133], v19 offset:2048
    ds_read_b64_tr_b16 v[134:135], v19 offset:3072
    s_waitcnt vmcnt(11) lgkmcnt(4)
    v_mfma_f32_32x32x16_bf16 v[64:79], v[144:147], a[32:35], v[64:79]
    ds_read_b64_tr_b16 v[136:137], v18 offset:4096
    ds_read_b64_tr_b16 v[138:139], v18 offset:5120
    s_add_u32 s55, s7, 5
    s_and_b32 s55, s55, 7
    s_add_u32 s55, s55, s3
    s_and_b32 s55, s55, 7
    s_lshl_b32 s55, s55, 12
    s_add_u32 s54, s48, s55
    buffer_load_dwordx4 a[80:83], v16, s[24:27], s54 offen offset:0 sc1
    v_mfma_f32_32x32x16_bf16 v[80:95], v[148:151], a[32:35], v[80:95]
    ds_read_b64_tr_b16 v[140:141], v19 offset:4096
    ds_read_b64_tr_b16 v[142:143], v19 offset:5120
    s_waitcnt vmcnt(11) lgkmcnt(4)
    v_mfma_f32_32x32x16_bf16 v[64:79], v[128:131], a[36:39], v[64:79]
    ds_read_b64_tr_b16 v[144:145], v18 offset:6144
    ds_read_b64_tr_b16 v[146:147], v18 offset:7168
    buffer_load_dwordx4 a[84:87], v16, s[24:27], s54 offen offset:1024 sc1
    v_mfma_f32_32x32x16_bf16 v[80:95], v[132:135], a[36:39], v[80:95]
    ds_read_b64_tr_b16 v[148:149], v19 offset:6144
    ds_read_b64_tr_b16 v[150:151], v19 offset:7168
    s_waitcnt vmcnt(11) lgkmcnt(4)
    v_mfma_f32_32x32x16_bf16 v[64:79], v[136:139], a[40:43], v[64:79]
    s_add_u32 s53, s7, 3
    s_and_b32 s53, s53, 7
    s_lshl_b32 s53, s53, 13
    v_add_u32 v20, s53, v2
    v_add_u32 v21, s53, v3
    ds_read_b64_tr_b16 v[128:129], v20 offset:0
    ds_read_b64_tr_b16 v[130:131], v20 offset:1024
    buffer_load_dwordx4 a[88:91], v16, s[24:27], s54 offen offset:2048 sc1
    v_mfma_f32_32x32x16_bf16 v[80:95], v[140:143], a[40:43], v[80:95]
    ds_read_b64_tr_b16 v[132:133], v21 offset:0
    ds_read_b64_tr_b16 v[134:135], v21 offset:1024
    s_waitcnt vmcnt(11) lgkmcnt(4)
    v_mfma_f32_32x32x16_bf16 v[64:79], v[144:147], a[44:47], v[64:79]
    ds_read_b64_tr_b16 v[136:137], v20 offset:2048
    ds_read_b64_tr_b16 v[138:139], v20 offset:3072
    buffer_load_dwordx4 a[92:95], v16, s[24:27], s54 offen offset:3072 sc1
    v_mfma_f32_32x32x16_bf16 v[80:95], v[148:151], a[44:47], v[80:95]
    ds_read_b64_tr_b16 v[140:141], v21 offset:2048
    ds_read_b64_tr_b16 v[142:143], v21 offset:3072
    s_waitcnt vmcnt(11) lgkmcnt(4)
    v_mfma_f32_32x32x16_bf16 v[64:79], v[128:131], a[48:51], v[64:79]
    ds_read_b64_tr_b16 v[144:145], v20 offset:4096
    ds_read_b64_tr_b16 v[146:147], v20 offset:5120
    s_add_u32 s55, s7, 6
    s_and_b32 s55, s55, 7
    s_add_u32 s55, s55, s3
    s_and_b32 s55, s55, 7
    s_lshl_b32 s55, s55, 12
    s_add_u32 s54, s48, s55
    buffer_load_dwordx4 a[96:99], v16, s[24:27], s54 offen offset:0 sc1
    v_mfma_f32_32x32x16_bf16 v[80:95], v[132:135], a[48:51], v[80:95]
    ds_read_b64_tr_b16 v[148:149], v21 offset:4096
    ds_read_b64_tr_b16 v[150:151], v21 offset:5120
    s_waitcnt vmcnt(11) lgkmcnt(4)
    v_mfma_f32_32x32x16_bf16 v[64:79], v[136:139], a[52:55], v[64:79]
    ds_read_b64_tr_b16 v[128:129], v20 offset:6144
    ds_read_b64_tr_b16 v[130:131], v20 offset:7168
    buffer_load_dwordx4 a[100:103], v16, s[24:27], s54 offen offset:1024 sc1
    v_mfma_f32_32x32x16_bf16 v[80:95], v[140:143], a[52:55], v[80:95]
    ds_read_b64_tr_b16 v[132:133], v21 offset:6144
    ds_read_b64_tr_b16 v[134:135], v21 offset:7168
    s_waitcnt vmcnt(11) lgkmcnt(4)
    v_mfma_f32_32x32x16_bf16 v[64:79], v[144:147], a[56:59], v[64:79]
    s_add_u32 s53, s7, 4
    s_and_b32 s53, s53, 7
    s_lshl_b32 s53, s53, 13
    v_add_u32 v18, s53, v2
    v_add_u32 v19, s53, v3
    ds_read_b64_tr_b16 v[136:137], v18 offset:0
    ds_read_b64_tr_b16 v[138:139], v18 offset:1024
    buffer_load_dwordx4 a[104:107], v16, s[24:27], s54 offen offset:2048 sc1
    v_mfma_f32_32x32x16_bf16 v[80:95], v[148:151], a[56:59], v[80:95]
    ds_read_b64_tr_b16 v[140:141], v19 offset:0
    ds_read_b64_tr_b16 v[142:143], v19 offset:1024
    s_waitcnt vmcnt(11) lgkmcnt(4)
    v_mfma_f32_32x32x16_bf16 v[64:79], v[128:131], a[60:63], v[64:79]
    ds_read_b64_tr_b16 v[144:145], v18 offset:2048
    ds_read_b64_tr_b16 v[146:147], v18 offset:3072
    buffer_load_dwordx4 a[108:111], v16, s[24:27], s54 offen offset:3072 sc1
    v_mfma_f32_32x32x16_bf16 v[80:95], v[132:135], a[60:63], v[80:95]
    ds_read_b64_tr_b16 v[148:149], v19 offset:2048
    ds_read_b64_tr_b16 v[150:151], v19 offset:3072
    s_waitcnt vmcnt(11) lgkmcnt(4)
    v_mfma_f32_32x32x16_bf16 v[64:79], v[136:139], a[64:67], v[64:79]
    ds_read_b64_tr_b16 v[128:129], v18 offset:4096
    ds_read_b64_tr_b16 v[130:131], v18 offset:5120
    s_add_u32 s55, s7, 7
    s_and_b32 s55, s55, 7
    s_add_u32 s55, s55, s3
    s_and_b32 s55, s55, 7
    s_lshl_b32 s55, s55, 12
    s_add_u32 s54, s48, s55
    buffer_load_dwordx4 a[112:115], v16, s[24:27], s54 offen offset:0 sc1
    v_mfma_f32_32x32x16_bf16 v[80:95], v[140:143], a[64:67], v[80:95]
    ds_read_b64_tr_b16 v[132:133], v19 offset:4096
    ds_read_b64_tr_b16 v[134:135], v19 offset:5120
    s_waitcnt vmcnt(11) lgkmcnt(4)
    v_mfma_f32_32x32x16_bf16 v[64:79], v[144:147], a[68:71], v[64:79]
    ds_read_b64_tr_b16 v[136:137], v18 offset:6144
    ds_read_b64_tr_b16 v[138:139], v18 offset:7168
    buffer_load_dwordx4 a[116:119], v16, s[24:27], s54 offen offset:1024 sc1
    v_mfma_f32_32x32x16_bf16 v[80:95], v[148:151], a[68:71], v[80:95]
    ds_read_b64_tr_b16 v[140:141], v19 offset:6144
    ds_read_b64_tr_b16 v[142:143], v19 offset:7168
    s_waitcnt vmcnt(11) lgkmcnt(4)
    v_mfma_f32_32x32x16_bf16 v[64:79], v[128:131], a[72:75], v[64:79]
    s_add_u32 s53, s7, 5
    s_and_b32 s53, s53, 7
    s_lshl_b32 s53, s53, 13
    v_add_u32 v20, s53, v2
    v_add_u32 v21, s53, v3
    ds_read_b64_tr_b16 v[144:145], v20 offset:0
    ds_read_b64_tr_b16 v[146:147], v20 offset:1024
    buffer_load_dwordx4 a[120:123], v16, s[24:27], s54 offen offset:2048 sc1
    v_mfma_f32_32x32x16_bf16 v[80:95], v[132:135], a[72:75], v[80:95]
    ds_read_b64_tr_b16 v[148:149], v21 offset:0
    ds_read_b64_tr_b16 v[150:151], v21 offset:1024
    s_waitcnt vmcnt(11) lgkmcnt(4)
    v_mfma_f32_32x32x16_bf16 v[64:79], v[136:139], a[76:79], v[64:79]
    ds_read_b64_tr_b16 v[128:129], v20 offset:2048
    ds_read_b64_tr_b16 v[130:131], v20 offset:3072
    buffer_load_dwordx4 a[124:127], v16, s[24:27], s54 offen offset:3072 sc1
    v_mfma_f32_32x32x16_bf16 v[80:95], v[140:143], a[76:79], v[80:95]
    ds_read_b64_tr_b16 v[132:133], v21 offset:2048
    ds_read_b64_tr_b16 v[134:135], v21 offset:3072
    s_waitcnt vmcnt(11) lgkmcnt(4)
    v_mfma_f32_32x32x16_bf16 v[64:79], v[144:147], a[80:83], v[64:79]
    ds_read_b64_tr_b16 v[136:137], v20 offset:4096
    ds_read_b64_tr_b16 v[138:139], v20 offset:5120
    v_mfma_f32_32x32x16_bf16 v[80:95], v[148:151], a[80:83], v[80:95]
    ds_read_b64_tr_b16 v[140:141], v21 offset:4096
    ds_read_b64_tr_b16 v[142:143], v21 offset:5120
    s_waitcnt vmcnt(10) lgkmcnt(4)
    v_mfma_f32_32x32x16_bf16 v[64:79], v[128:131], a[84:87], v[64:79]
    ds_read_b64_tr_b16 v[144:145], v20 offset:6144
    ds_read_b64_tr_b16 v[146:147], v20 offset:7168
    v_mfma_f32_32x32x16_bf16 v[80:95], v[132:135], a[84:87], v[80:95]
    ds_read_b64_tr_b16 v[148:149], v21 offset:6144
    ds_read_b64_tr_b16 v[150:151], v21 offset:7168
    s_waitcnt vmcnt(9) lgkmcnt(4)
    v_mfma_f32_32x32x16_bf16 v[64:79], v[136:139], a[88:91], v[64:79]
    s_add_u32 s53, s7, 6
    s_and_b32 s53, s53, 7
    s_lshl_b32 s53, s53, 13
    v_add_u32 v18, s53, v2
    v_add_u32 v19, s53, v3
    ds_read_b64_tr_b16 v[128:129], v18 offset:0
    ds_read_b64_tr_b16 v[130:131], v18 offset:1024
    v_mfma_f32_32x32x16_bf16 v[80:95], v[140:143], a[88:91], v[80:95]
    ds_read_b64_tr_b16 v[132:133], v19 offset:0
    ds_read_b64_tr_b16 v[134:135], v19 offset:1024
    s_waitcnt vmcnt(8) lgkmcnt(4)
    v_mfma_f32_32x32x16_bf16 v[64:79], v[144:147], a[92:95], v[64:79]
    ds_read_b64_tr_b16 v[136:137], v18 offset:2048
    ds_read_b64_tr_b16 v[138:139], v18 offset:3072
    v_mfma_f32_32x32x16_bf16 v[80:95], v[148:151], a[92:95], v[80:95]
    ds_read_b64_tr_b16 v[140:141], v19 offset:2048
    ds_read_b64_tr_b16 v[142:143], v19 offset:3072
    s_waitcnt vmcnt(7) lgkmcnt(4)
    v_mfma_f32_32x32x16_bf16 v[64:79], v[128:131], a[96:99], v[64:79]
    ds_read_b64_tr_b16 v[144:145], v18 offset:4096
    ds_read_b64_tr_b16 v[146:147], v18 offset:5120
    v_mfma_f32_32x32x16_bf16 v[80:95], v[132:135], a[96:99], v[80:95]
    ds_read_b64_tr_b16 v[148:149], v19 offset:4096
    ds_read_b64_tr_b16 v[150:151], v19 offset:5120
    s_waitcnt vmcnt(6) lgkmcnt(4)
    v_mfma_f32_32x32x16_bf16 v[64:79], v[136:139], a[100:103], v[64:79]
    ds_read_b64_tr_b16 v[128:129], v18 offset:6144
    ds_read_b64_tr_b16 v[130:131], v18 offset:7168
    v_mfma_f32_32x32x16_bf16 v[80:95], v[140:143], a[100:103], v[80:95]
    ds_read_b64_tr_b16 v[132:133], v19 offset:6144
    ds_read_b64_tr_b16 v[134:135], v19 offset:7168
    s_waitcnt vmcnt(5) lgkmcnt(4)
    v_mfma_f32_32x32x16_bf16 v[64:79], v[144:147], a[104:107], v[64:79]
    s_add_u32 s53, s7, 7
    s_and_b32 s53, s53, 7
    s_lshl_b32 s53, s53, 13
    v_add_u32 v20, s53, v2
    v_add_u32 v21, s53, v3
    ds_read_b64_tr_b16 v[136:137], v20 offset:0
    ds_read_b64_tr_b16 v[138:139], v20 offset:1024
    v_mfma_f32_32x32x16_bf16 v[80:95], v[148:151], a[104:107], v[80:95]
    ds_read_b64_tr_b16 v[140:141], v21 offset:0
    ds_read_b64_tr_b16 v[142:143], v21 offset:1024
    s_waitcnt vmcnt(4) lgkmcnt(4)
    v_mfma_f32_32x32x16_bf16 v[64:79], v[128:131], a[108:111], v[64:79]
    ds_read_b64_tr_b16 v[144:145], v20 offset:2048
    ds_read_b64_tr_b16 v[146:147], v20 offset:3072
    v_mfma_f32_32x32x16_bf16 v[80:95], v[132:135], a[108:111], v[80:95]
    ds_read_b64_tr_b16 v[148:149], v21 offset:2048
    ds_read_b64_tr_b16 v[150:151], v21 offset:3072
    s_waitcnt vmcnt(3) lgkmcnt(4)
    v_mfma_f32_32x32x16_bf16 v[64:79], v[136:139], a[112:115], v[64:79]
    ds_read_b64_tr_b16 v[128:129], v20 offset:4096
    ds_read_b64_tr_b16 v[130:131], v20 offset:5120
    v_mfma_f32_32x32x16_bf16 v[80:95], v[140:143], a[112:115], v[80:95]
    ds_read_b64_tr_b16 v[132:133], v21 offset:4096
    ds_read_b64_tr_b16 v[134:135], v21 offset:5120
    s_waitcnt vmcnt(2) lgkmcnt(4)
    v_mfma_f32_32x32x16_bf16 v[64:79], v[144:147], a[116:119], v[64:79]
    ds_read_b64_tr_b16 v[136:137], v20 offset:6144
    ds_read_b64_tr_b16 v[138:139], v20 offset:7168
    v_mfma_f32_32x32x16_bf16 v[80:95], v[148:151], a[116:119], v[80:95]
    ds_read_b64_tr_b16 v[140:141], v21 offset:6144
    ds_read_b64_tr_b16 v[142:143], v21 offset:7168
    s_waitcnt vmcnt(1) lgkmcnt(4)
    v_mfma_f32_32x32x16_bf16 v[64:79], v[128:131], a[120:123], v[64:79]
    v_mfma_f32_32x32x16_bf16 v[80:95], v[132:135], a[120:123], v[80:95]
    s_waitcnt vmcnt(0) lgkmcnt(0)
    v_mfma_f32_32x32x16_bf16 v[64:79], v[136:139], a[124:127], v[64:79]
    v_mfma_f32_32x32x16_bf16 v[80:95], v[140:143], a[124:127], v[80:95]
    s_nop 10
    v_pk_mul_f32 v[64:65], v[64:65], v[96:97] op_sel_hi:[1,0]
    v_pk_mul_f32 v[66:67], v[66:67], v[96:97] op_sel_hi:[1,0]
    ds_write_b128 v4, v[64:67] offset:0
    v_pk_mul_f32 v[68:69], v[68:69], v[96:97] op_sel_hi:[1,0]
    v_pk_mul_f32 v[70:71], v[70:71], v[96:97] op_sel_hi:[1,0]
    ds_write_b128 v5, v[68:71] offset:0
    v_pk_mul_f32 v[72:73], v[72:73], v[96:97] op_sel_hi:[1,0]
    v_pk_mul_f32 v[74:75], v[74:75], v[96:97] op_sel_hi:[1,0]
    ds_write_b128 v6, v[72:75] offset:0
    v_pk_mul_f32 v[76:77], v[76:77], v[96:97] op_sel_hi:[1,0]
    v_pk_mul_f32 v[78:79], v[78:79], v[96:97] op_sel_hi:[1,0]
    ds_write_b128 v7, v[76:79] offset:0
    v_pk_mul_f32 v[80:81], v[80:81], v[96:97] op_sel_hi:[1,0]
    v_pk_mul_f32 v[82:83], v[82:83], v[96:97] op_sel_hi:[1,0]
    ds_write_b128 v4, v[80:83] offset:128
    v_pk_mul_f32 v[84:85], v[84:85], v[96:97] op_sel_hi:[1,0]
    v_pk_mul_f32 v[86:87], v[86:87], v[96:97] op_sel_hi:[1,0]
    ds_write_b128 v5, v[84:87] offset:128
    v_pk_mul_f32 v[88:89], v[88:89], v[96:97] op_sel_hi:[1,0]
    v_pk_mul_f32 v[90:91], v[90:91], v[96:97] op_sel_hi:[1,0]
    ds_write_b128 v6, v[88:91] offset:128
    v_pk_mul_f32 v[92:93], v[92:93], v[96:97] op_sel_hi:[1,0]
    v_pk_mul_f32 v[94:95], v[94:95], v[96:97] op_sel_hi:[1,0]
    ds_write_b128 v7, v[92:95] offset:128
    s_waitcnt lgkmcnt(0)
    s_barrier
    ds_read_b128 v[168:171], v8 offset:0
    ds_read_b128 v[172:175], v9 offset:0
    ds_read_b128 v[176:179], v8 offset:16384
    ds_read_b128 v[180:183], v9 offset:16384
    ds_read_b128 v[184:187], v8 offset:2048
    ds_read_b128 v[188:191], v9 offset:2048
    ds_read_b128 v[192:195], v8 offset:18432
    ds_read_b128 v[196:199], v9 offset:18432
    s_waitcnt lgkmcnt(4)
    v_pk_add_f32 v[168:169], v[168:169], v[176:177]
    v_pk_add_f32 v[170:171], v[170:171], v[178:179]
    v_pk_add_f32 v[172:173], v[172:173], v[180:181]
    v_pk_add_f32 v[174:175], v[174:175], v[182:183]
    v_cvt_pk_bf16_f32 v176, v168, v169
    v_cvt_pk_bf16_f32 v177, v170, v171
    v_cvt_pk_bf16_f32 v178, v172, v173
    v_cvt_pk_bf16_f32 v179, v174, v175
    buffer_store_dwordx4 v[176:179], v14, s[28:31], s50 offen
    s_waitcnt lgkmcnt(0)
    v_pk_add_f32 v[184:185], v[184:185], v[192:193]
    v_pk_add_f32 v[186:187], v[186:187], v[194:195]
    v_pk_add_f32 v[188:189], v[188:189], v[196:197]
    v_pk_add_f32 v[190:191], v[190:191], v[198:199]
    v_cvt_pk_bf16_f32 v192, v184, v185
    v_cvt_pk_bf16_f32 v193, v186, v187
    v_cvt_pk_bf16_f32 v194, v188, v189
    v_cvt_pk_bf16_f32 v195, v190, v191
    buffer_store_dwordx4 v[192:195], v14, s[28:31], s51 offen
    s_cmp_eq_u32 s92, 0
    s_cbranch_scc0 L_noepB
    s_cmp_eq_u32 s40, 0
    s_cbranch_scc0 L_noepB
    v_mov_b32 v27, 0
    s_mov_b64 exec, 1
    buffer_store_dword v26, v27, s[24:27], 0 offen sc1
    s_mov_b64 exec, -1
L_noepB:
    s_endpgm
L_end:
    s_endpgm
.section .rodata,"a"
.p2align 6
.amdhsa_kernel gated_mix__linear_attn_block__linear_kernel_hedgehog__prompt_kernel
  .amdhsa_next_free_vgpr 512
  .amdhsa_next_free_sgpr 102
  .amdhsa_accum_offset 256
  .amdhsa_group_segment_fixed_size 0
  .amdhsa_kernarg_size 88
  .amdhsa_user_sgpr_count 2
  .amdhsa_user_sgpr_kernarg_segment_ptr 1
  .amdhsa_system_sgpr_workgroup_id_x 1
.end_amdhsa_kernel
```
